```python
import torch

def _softmax(x, axis=-1):
    return torch.softmax(x, dim=axis)
def _gelu(x):
    return torch.nn.functional.gelu(x, approximate="tanh")
def _silu(x):
    return torch.nn.functional.silu(x)
def _sigmoid(x):
    return torch.sigmoid(x)
def _layernorm(x, axis=-1, eps=1e-5):
    m = x.mean(dim=axis, keepdim=True)
    v = x.var(dim=axis, keepdim=True, unbiased=False)
    return (x - m) / torch.sqrt(v + eps)
def _scatter_add(tgt, idx, src, axis=0):
    return tgt.clone().index_add_(axis, idx, src)
def _segment_sum(src, seg, n):
    out = torch.zeros((n,) + src.shape[1:], dtype=src.dtype)
    return out.index_add_(0, seg, src)
def _pad(x, pw):
    flat = tuple(v for pair in reversed(pw) for v in pair)
    return torch.nn.functional.pad(x, flat)

kernel_name = 'sequential_preLN__softmax_full_mha__swiglu_ffn__prompt'

def setup_inputs():

    _w = (lambda a: (lambda t: t.to(torch.bfloat16) if t.is_floating_point() else t)(torch.as_tensor(a)))
    def _A_setup():
        B, S, D = 1, 2048, 640
        return {
            "x": _w((lambda *s: torch.randn(*s, dtype=torch.bfloat16) * 0.05)(B, S, D)),
            "wqkv": _w((lambda *s: torch.randn(*s, dtype=torch.bfloat16) * 0.05)(D, 3 * D)),
            "wo": _w((lambda *s: torch.randn(*s, dtype=torch.bfloat16) * 0.05)(D, D)),
        }
    _A_in = _A_setup()

    def _B_setup():
        B, S, D, F = 1, 2048, 640, 1728
        return {
            "x": _w((lambda *s: torch.randn(*s, dtype=torch.bfloat16) * 0.05)(B, S, D)),
            "w_gate": _w((lambda *s: torch.randn(*s, dtype=torch.bfloat16) * 0.05)(D, F)),
            "w_up": _w((lambda *s: torch.randn(*s, dtype=torch.bfloat16) * 0.05)(D, F)),
            "w_down": _w((lambda *s: torch.randn(*s, dtype=torch.bfloat16) * 0.05)(F, D)),
        }
    _B_in = _B_setup()

    return {
        "A_x": _A_in["x"],
        "A_wqkv": _A_in["wqkv"],
        "A_wo": _A_in["wo"],
        "B_x": _B_in["x"],
        "B_w_gate": _B_in["w_gate"],
        "B_w_up": _B_in["w_up"],
        "B_w_down": _B_in["w_down"],
    }

def reference(A_x, A_wqkv, A_wo, B_x, B_w_gate, B_w_up, B_w_down):
    def _A_ref(x, wqkv, wo):
        B, S, D = x.shape
        H = 32; Dh = D // H
        qkv = (lambda x, *d: x.permute(*d))((x @ wqkv).reshape(B, S, 3, H, Dh), 2, 0, 3, 1, 4)
        q, k, v = qkv[0], qkv[1], qkv[2]
        scale = Dh ** -0.5
        scores = torch.einsum("bhqd,bhkd->bhqk", q, k) * scale
        p = _softmax(scores, axis=-1)
        o = torch.einsum("bhqk,bhkd->bhqd", p, v)
        return (lambda x, *d: x.permute(*d))(o, 0, 2, 1, 3).reshape(B, S, D) @ wo

    def _B_ref(x, w_gate, w_up, w_down):
        g = _silu(x @ w_gate)
        u = x @ w_up
        return (g * u) @ w_down

    x = A_x
    h = x + _A_ref(_layernorm(x, axis=-1), A_wqkv, A_wo)
    h2 = h + _B_ref(_layernorm(h, axis=-1), B_w_gate, B_w_up, B_w_down)
    return h2
```

```asm
; @launch grid=(256,1,1) block=(768,1,1) lds=163840
.amdgcn_target "amdgcn-amd-amdhsa--gfx950"
.text
.globl sequential_preLN__softmax_full_mha__swiglu_ffn__prompt_kernel
.p2align 8
.type sequential_preLN__softmax_full_mha__swiglu_ffn__prompt_kernel,@function
sequential_preLN__softmax_full_mha__swiglu_ffn__prompt_kernel:
  s_cmp_ge_u32 s2, 256
  s_cbranch_scc1 K_END
  s_load_dwordx4 s[20:23], s[0:1], 0
  s_load_dwordx2 s[24:25], s[0:1], 72
  v_lshrrev_b32 v1, 6, v0
  v_and_b32 v0, 63, v0
  v_readfirstlane_b32 s16, v1
  s_nop 2
  s_cmp_lg_u32 s16, 7
  s_cbranch_scc1 PCS_2
  s_getpc_b64 s[40:41]
PC_1:
  s_mov_b32 s42, CODE_END-PC_1
  s_mov_b32 s43, 0x20000
  v_lshlrev_b32 v3, 7, v0
  s_lshr_b32 s44, s2, 3
  s_mul_i32 s44, s44, 1280
  s_mov_b64 exec, 0x3ff
  buffer_load_dword v5, v3, s[40:43], s44 offen
  s_mov_b64 exec, -1
PCS_2:
  s_and_b32 s3, s2, 7
  s_lshr_b32 s17, s2, 3
  s_cmp_ge_u32 s17, 30
  s_cbranch_scc1 KA_SPARE
  s_and_b32 s18, s3, 1
  s_mul_i32 s18, s18, 30
  s_add_u32 s18, s18, s17
  s_lshr_b32 s19, s3, 1
  s_lshl_b32 s19, s19, 2
  s_and_b32 s26, s18, 3
  s_add_u32 s17, s19, s26
  s_lshr_b32 s18, s18, 2
  s_cmp_lt_u32 s16, 8
  s_cbranch_scc1 KA_NOTL
  s_sub_u32 s16, s16, 8
  v_lshrrev_b32 v1, 3, v0
  v_mul_u32_u24 v1, 1280, v1
  v_lshrrev_b32 v2, 4, v0
  v_xor_b32 v4, v0, v2
  v_and_b32 v4, 7, v4
  v_lshl_add_u32 v4, v4, 4, v1
  v_xor_b32 v5, 64, v4
  s_lshl_b32 s32, s17, 2
  s_add_u32 s32, s32, s16
  s_mul_i32 s38, s32, 30720
  s_mul_i32 s32, s32, 40960
  s_lshl_b32 s34, s16, 12
  s_mov_b32 m0, s34
  s_mov_b32 s7, 0x20000
  s_mov_b32 s6, 2621440
  v_add_u32 v6, 18432, v4
  v_add_u32 v7, 27648, v5
  v_add_u32 v5, 9216, v5
  s_waitcnt lgkmcnt(0)
  s_mov_b64 s[4:5], s[20:21]
  buffer_load_dwordx4 v4, s[4:7], s32 offen offset:0 lds
  buffer_load_dwordx4 v5, s[4:7], s32 offen offset:1024 lds
  buffer_load_dwordx4 v6, s[4:7], s32 offen offset:2048 lds
  buffer_load_dwordx4 v7, s[4:7], s32 offen offset:3072 lds
  v_bfe_u32 v1, v0, 2, 2
  v_mul_u32_u24 v1, 3840, v1
  v_lshl_add_u32 v1, v2, 6, v1
  v_and_b32 v2, 3, v0
  v_lshl_add_u32 v8, v2, 4, v1
  s_mul_i32 s33, s16, 61440
  s_lshl_b32 s35, s18, 8
  s_add_u32 s33, s33, s35
  s_add_u32 s38, s38, s35
  s_mov_b64 s[8:9], s[22:23]
  s_mov_b32 s10, 2457600
  s_mov_b32 s11, 0x20000
  s_add_u32 m0, s34, 65536
  s_add_u32 s32, s32, 128
  s_mov_b32 s36, 1
  v_add_u32 v9, 14336, v8
  v_add_u32 v10, 28672, v8
  v_add_u32 v11, 43008, v8
  buffer_load_dwordx4 v8, s[8:11], s33 offen offset:0 lds
  buffer_load_dwordx4 v9, s[8:11], s33 offen offset:1024 lds
  buffer_load_dwordx4 v10, s[8:11], s33 offen offset:2048 lds
  buffer_load_dwordx4 v11, s[8:11], s33 offen offset:3072 lds
  s_add_u32 s33, s33, 245760
  s_add_u32 s34, s34, 16384
  s_and_b32 s34, s34, 0xffff
  s_mov_b32 m0, s34
  s_add_u32 s36, s36, 1
  buffer_load_dwordx4 v4, s[4:7], s32 offen offset:0 lds
  buffer_load_dwordx4 v5, s[4:7], s32 offen offset:1024 lds
  buffer_load_dwordx4 v6, s[4:7], s32 offen offset:2048 lds
  buffer_load_dwordx4 v7, s[4:7], s32 offen offset:3072 lds
  s_add_u32 m0, s34, 65536
  s_add_u32 s32, s32, 128
  buffer_load_dwordx4 v8, s[8:11], s33 offen offset:0 lds
  buffer_load_dwordx4 v9, s[8:11], s33 offen offset:1024 lds
  buffer_load_dwordx4 v10, s[8:11], s33 offen offset:2048 lds
  buffer_load_dwordx4 v11, s[8:11], s33 offen offset:3072 lds
  s_add_u32 s33, s33, 245760
  s_add_u32 s34, s34, 16384
  s_and_b32 s34, s34, 0xffff
  s_mov_b32 s12, s24
  s_mov_b32 s13, s25
  s_mov_b32 s14, 34603008
  s_mov_b32 s15, 0x20000
  s_add_u32 s54, s24, 23863296
  s_addc_u32 s55, s25, 0
  s_load_dword s54, s[54:55], 0
  s_waitcnt vmcnt(8)
  s_barrier
  s_mov_b32 m0, s34
  s_add_u32 s36, s36, 1
  buffer_load_dwordx4 v4, s[4:7], s32 offen offset:0 lds
  buffer_load_dwordx4 v5, s[4:7], s32 offen offset:1024 lds
  buffer_load_dwordx4 v6, s[4:7], s32 offen offset:2048 lds
  buffer_load_dwordx4 v7, s[4:7], s32 offen offset:3072 lds
  s_add_u32 m0, s34, 65536
  s_add_u32 s32, s32, 128
  buffer_load_dwordx4 v8, s[8:11], s33 offen offset:0 lds
  buffer_load_dwordx4 v9, s[8:11], s33 offen offset:1024 lds
  buffer_load_dwordx4 v10, s[8:11], s33 offen offset:2048 lds
  buffer_load_dwordx4 v11, s[8:11], s33 offen offset:3072 lds
  s_add_u32 s33, s33, 245760
  s_add_u32 s34, s34, 16384
  s_and_b32 s34, s34, 0xffff
  s_lshl_b32 s35, s16, 11
  s_add_u32 m0, s35, 135168
  s_add_u32 s39, s38, 1966080
  buffer_load_dwordx4 v8, s[8:11], s38 offen offset:0 lds
  buffer_load_dwordx4 v9, s[8:11], s38 offen offset:1024 lds
  s_add_u32 m0, s35, 143360
  s_nop 0
  buffer_load_dwordx4 v8, s[8:11], s39 offen offset:0 lds
  buffer_load_dwordx4 v9, s[8:11], s39 offen offset:1024 lds
  s_waitcnt vmcnt(12)
  s_barrier
  s_mov_b32 m0, s34
  s_add_u32 s36, s36, 1
  buffer_load_dwordx4 v4, s[4:7], s32 offen offset:0 lds
  buffer_load_dwordx4 v5, s[4:7], s32 offen offset:1024 lds
  buffer_load_dwordx4 v6, s[4:7], s32 offen offset:2048 lds
  buffer_load_dwordx4 v7, s[4:7], s32 offen offset:3072 lds
  s_add_u32 m0, s34, 65536
  s_add_u32 s32, s32, 128
  buffer_load_dwordx4 v8, s[8:11], s33 offen offset:0 lds
  buffer_load_dwordx4 v9, s[8:11], s33 offen offset:1024 lds
  buffer_load_dwordx4 v10, s[8:11], s33 offen offset:2048 lds
  buffer_load_dwordx4 v11, s[8:11], s33 offen offset:3072 lds
  s_add_u32 s33, s33, 245760
  s_add_u32 s34, s34, 16384
  s_and_b32 s34, s34, 0xffff
  s_waitcnt vmcnt(12)
  s_barrier
  s_branch KA_L2
KA_L1:
  s_waitcnt vmcnt(8)
  s_barrier
KA_L2:
  s_mov_b32 m0, s34
  s_add_u32 s36, s36, 1
  buffer_load_dwordx4 v4, s[4:7], s32 offen offset:0 lds
  buffer_load_dwordx4 v5, s[4:7], s32 offen offset:1024 lds
  buffer_load_dwordx4 v6, s[4:7], s32 offen offset:2048 lds
  buffer_load_dwordx4 v7, s[4:7], s32 offen offset:3072 lds
  s_add_u32 m0, s34, 65536
  s_add_u32 s32, s32, 128
  buffer_load_dwordx4 v8, s[8:11], s33 offen offset:0 lds
  buffer_load_dwordx4 v9, s[8:11], s33 offen offset:1024 lds
  buffer_load_dwordx4 v10, s[8:11], s33 offen offset:2048 lds
  buffer_load_dwordx4 v11, s[8:11], s33 offen offset:3072 lds
  s_add_u32 s33, s33, 245760
  s_add_u32 s34, s34, 16384
  s_and_b32 s34, s34, 0xffff
  s_cmp_lt_u32 s36, 9
  s_cbranch_scc1 KA_L1
  s_lshl_b32 s41, s17, 11
  s_lshl_b32 s42, s16, 9
  s_add_u32 s41, s41, s42
  s_add_u32 s41, s41, 23887872
  s_lshl_b32 s42, s18, 14
  s_lshl_b32 s43, s16, 8
  s_add_u32 s42, s42, s43
  s_add_u32 s42, s42, 24641536
  s_add_u32 s43, s42, 8192
  v_and_b32 v32, 31, v0
  v_lshlrev_b32 v32, 4, v32
  v_lshrrev_b32 v33, 4, v0
  v_mul_u32_u24 v33, 768, v33
  v_lshl_add_u32 v33, v0, 4, v33
  v_add_u32 v34, 4096, v33
  s_mov_b32 s39, 0
  s_setprio 3
  s_waitcnt vmcnt(8) lgkmcnt(0)
  s_barrier
  buffer_load_dwordx4 v[12:15], v33, s[12:15], s42 offen sc1
  buffer_load_dwordx4 v[16:19], v34, s[12:15], s42 offen sc1
  buffer_load_dwordx4 v[20:23], v33, s[12:15], s43 offen sc1
  buffer_load_dwordx4 v[24:27], v34, s[12:15], s43 offen sc1
  buffer_load_dwordx4 v[28:31], v32, s[12:15], s41 offen sc1
  s_mov_b32 m0, s34
  s_add_u32 s36, s36, 1
  buffer_load_dwordx4 v4, s[4:7], s32 offen offset:0 lds
  buffer_load_dwordx4 v5, s[4:7], s32 offen offset:1024 lds
  buffer_load_dwordx4 v6, s[4:7], s32 offen offset:2048 lds
  buffer_load_dwordx4 v7, s[4:7], s32 offen offset:3072 lds
  s_add_u32 m0, s34, 65536
  s_add_u32 s32, s32, 128
  buffer_load_dwordx4 v8, s[8:11], s33 offen offset:0 lds
  buffer_load_dwordx4 v9, s[8:11], s33 offen offset:1024 lds
  buffer_load_dwordx4 v10, s[8:11], s33 offen offset:2048 lds
  buffer_load_dwordx4 v11, s[8:11], s33 offen offset:3072 lds
  s_add_u32 s33, s33, 245760
  s_add_u32 s34, s34, 16384
  s_and_b32 s34, s34, 0xffff
  s_add_u32 s54, s54, 1
  s_waitcnt vmcnt(13)
  s_barrier
  s_waitcnt vmcnt(8)
  s_branch KA_G1
KA_G2:
  s_add_u32 s39, s39, 1
  s_cmp_gt_u32 s39, 400000
  s_cbranch_scc1 KA_G3
  buffer_load_dwordx4 v[12:15], v33, s[12:15], s42 offen sc1
  buffer_load_dwordx4 v[16:19], v34, s[12:15], s42 offen sc1
  buffer_load_dwordx4 v[20:23], v33, s[12:15], s43 offen sc1
  buffer_load_dwordx4 v[24:27], v34, s[12:15], s43 offen sc1
  buffer_load_dwordx4 v[28:31], v32, s[12:15], s41 offen sc1
  s_waitcnt vmcnt(0)
KA_G1:
  v_xor_b32 v13, s54, v13
  v_xor_b32 v15, s54, v15
  v_xor_b32 v17, s54, v17
  v_xor_b32 v19, s54, v19
  v_xor_b32 v21, s54, v21
  v_xor_b32 v23, s54, v23
  v_xor_b32 v25, s54, v25
  v_xor_b32 v27, s54, v27
  v_xor_b32 v29, s54, v29
  v_xor_b32 v31, s54, v31
  v_or3_b32 v13, v13, v15, v17
  v_or3_b32 v19, v19, v21, v23
  v_or3_b32 v25, v25, v27, v29
  v_or3_b32 v13, v13, v19, v25
  v_or_b32 v13, v13, v31
  v_cmp_ne_u32 vcc, 0, v13
  s_nop 4
  s_cbranch_vccnz KA_G2
KA_G3:
  s_lshl_b32 s41, s16, 7
  s_add_u32 s41, s41, 131072
  v_lshrrev_b32 v32, 2, v32
  v_add_u32 v32, s41, v32
  ds_write_b32 v32, v28
  ds_write_b32 v32, v30 offset:512
  v_add_f32 v12, v12, v16
  v_add_f32 v13, v14, v18
  v_add_f32 v20, v20, v24
  v_add_f32 v21, v22, v26
  v_pk_add_f32 v[12:13], v[12:13], v[20:21]
  v_mov_b32 v14, v12
  v_mov_b32 v15, v13
  s_nop 1
  v_permlane16_swap_b32 v12, v14
  v_permlane16_swap_b32 v13, v15
  v_pk_add_f32 v[12:13], v[12:13], v[14:15]
  v_mov_b32 v14, v12
  v_mov_b32 v15, v13
  s_nop 1
  v_permlane32_swap_b32 v12, v14
  v_permlane32_swap_b32 v13, v15
  v_pk_add_f32 v[12:13], v[12:13], v[14:15]
  v_and_b32 v33, 15, v0
  v_lshl_add_u32 v33, v33, 3, s41
  ds_write_b64 v33, v[12:13] offset:1024
  s_waitcnt vmcnt(0) lgkmcnt(0)
  s_barrier
  s_branch K2_LOAD
KA_NOTL:
  s_waitcnt lgkmcnt(0)
  s_mov_b32 s12, s24
  s_mov_b32 s13, s25
  s_mov_b32 s14, 34603008
  s_mov_b32 s15, 0x20000
  s_mov_b32 s4, s20
  s_mov_b32 s5, s21
  s_mov_b32 s6, 2621440
  s_mov_b32 s7, 0x20000
  s_add_u32 s54, s24, 23863296
  s_addc_u32 s55, s25, 0
  s_load_dword s54, s[54:55], 0
  s_bfe_u32 s27, s2, 0x30000
  s_lshl_b32 s27, s27, 5
  s_lshr_b32 s34, s2, 3
  s_add_u32 s27, s27, s34
  s_lshl_b32 s27, s27, 3
  s_add_u32 s27, s27, s16
  s_mul_i32 s34, s27, 1280
  v_lshlrev_b32 v3, 4, v0
  v_lshrrev_b32 v4, 4, v0
  v_lshl_add_u32 v4, v4, 24, v3
  buffer_load_dwordx4 v[120:123], v3, s[4:7], s34 offen
  buffer_load_dwordx4 v[124:127], v4, s[4:7], s34 offen offset:1024
  v_and_b32 v1, 31, v0
  v_lshrrev_b32 v2, 5, v0
  s_mul_i32 s19, s18, 205
  s_lshr_b32 s19, s19, 10
  s_mul_i32 s26, s19, 5
  s_sub_u32 s26, s18, s26
  s_lshr_b32 s32, s16, 2
  s_and_b32 s33, s16, 3
  s_lshl_b32 s34, s32, 13
  v_bfe_u32 v3, v1, 1, 3
  v_xor_b32 v3, v3, v2
  v_lshl_add_u32 v4, v1, 7, s34
  v_xor_b32 v6, 0, v3
  v_lshl_add_u32 v6, v6, 4, v4
  v_xor_b32 v7, 2, v3
  v_lshl_add_u32 v7, v7, 4, v4
  v_xor_b32 v8, 4, v3
  v_lshl_add_u32 v8, v8, 4, v4
  v_xor_b32 v9, 6, v3
  v_lshl_add_u32 v9, v9, 4, v4
  v_bfe_u32 v3, v0, 2, 2
  v_lshlrev_b32 v3, 6, v3
  v_lshl_add_u32 v3, v2, 11, v3
  v_bfe_u32 v4, v0, 4, 1
  v_lshl_add_u32 v3, v4, 5, v3
  v_and_b32 v4, 3, v0
  v_lshl_add_u32 v3, v4, 3, v3
  s_lshl_b32 s34, s33, 8
  s_add_u32 s34, s34, 65536
  v_add_u32 v10, s34, v3
  s_mov_b32 s44, 0
  s_mov_b32 s45, 10
  v_mov_b32 v11, v6
  v_mov_b32 v12, v7
  v_mov_b32 v13, v8
  v_mov_b32 v14, v9
  v_mov_b32 v15, v10
  v_mov_b32 v16, 0
  v_mov_b32 v17, 0
  v_mov_b32 v18, 0
  v_mov_b32 v19, 0
  v_mov_b32 v20, 0
  v_mov_b32 v21, 0
  v_mov_b32 v22, 0
  v_mov_b32 v23, 0
  v_mov_b32 v24, 0
  v_mov_b32 v25, 0
  v_mov_b32 v26, 0
  v_mov_b32 v27, 0
  v_mov_b32 v28, 0
  v_mov_b32 v29, 0
  v_mov_b32 v30, 0
  v_mov_b32 v31, 0
  v_mov_b32 v32, 0
  v_mov_b32 v33, 0
  v_mov_b32 v34, 0
  v_mov_b32 v35, 0
  v_mov_b32 v36, 0
  v_mov_b32 v37, 0
  v_mov_b32 v38, 0
  v_mov_b32 v39, 0
  v_mov_b32 v40, 0
  v_mov_b32 v41, 0
  v_mov_b32 v42, 0
  v_mov_b32 v43, 0
  v_mov_b32 v44, 0
  v_mov_b32 v45, 0
  v_mov_b32 v46, 0
  v_mov_b32 v47, 0
  s_cmp_eq_u32 s19, 2
  s_cbranch_scc1 KA_V
  s_cmp_eq_u32 s19, 0
  s_mov_b32 s36, 163840
  s_mov_b32 s37, 10240
  s_mov_b32 s38, 3145728
  s_cmov_b32 s36, 81920
  s_cmov_b32 s37, 5120
  s_cmov_b32 s38, 0
  s_cselect_b32 s39, 0, 12
  s_mul_i32 s37, s37, s17
  s_add_u32 s38, s38, s37
  v_lshrrev_b32 v100, 1, v1
  v_xor_b32 v100, v100, v1
  v_bfe_u32 v100, v100, 2, 1
  v_mul_u32_u24 v100, s39, v100
  v_xor_b32 v100, v100, v1
  s_lshl_b32 s37, s32, 9
  s_add_u32 s37, s37, s38
  s_add_u32 s37, s37, 4096
  v_lshl_add_u32 v97, v100, 3, s37
  v_mad_u32_u24 v97, v2, s36, v97
  s_lshl_b32 s37, s32, 11
  s_add_u32 s37, s37, s38
  v_lshl_add_u32 v96, v100, 4, s37
  v_lshl_add_u32 v96, v2, 10, v96
  s_lshl_b32 s37, s26, 4
  s_lshl_b32 s38, s33, 2
  s_add_u32 s37, s37, s38
  s_mul_i32 s38, s37, 205
  s_lshr_b32 s38, s38, 10
  s_mul_i32 s39, s38, 5
  s_sub_u32 s39, s37, s39
  s_lshl_b32 s38, s38, 1
  s_cmp_ge_u32 s39, 3
  s_addc_u32 s38, s38, 0
  s_mul_i32 s4, s38, s36
  s_cmp_eq_u32 s39, 1
  s_cselect_b32 s38, 512, 0
  s_cmp_eq_u32 s39, 4
  s_cselect_b32 s38, 512, s38
  s_add_u32 s4, s4, s38
  s_mov_b32 s8, s39
  s_add_u32 s37, s37, 1
  s_mul_i32 s38, s37, 205
  s_lshr_b32 s38, s38, 10
  s_mul_i32 s39, s38, 5
  s_sub_u32 s39, s37, s39
  s_lshl_b32 s38, s38, 1
  s_cmp_ge_u32 s39, 3
  s_addc_u32 s38, s38, 0
  s_mul_i32 s5, s38, s36
  s_cmp_eq_u32 s39, 1
  s_cselect_b32 s38, 512, 0
  s_cmp_eq_u32 s39, 4
  s_cselect_b32 s38, 512, s38
  s_add_u32 s5, s5, s38
  s_mov_b32 s9, s39
  s_add_u32 s37, s37, 1
  s_mul_i32 s38, s37, 205
  s_lshr_b32 s38, s38, 10
  s_mul_i32 s39, s38, 5
  s_sub_u32 s39, s37, s39
  s_lshl_b32 s38, s38, 1
  s_cmp_ge_u32 s39, 3
  s_addc_u32 s38, s38, 0
  s_mul_i32 s6, s38, s36
  s_cmp_eq_u32 s39, 1
  s_cselect_b32 s38, 512, 0
  s_cmp_eq_u32 s39, 4
  s_cselect_b32 s38, 512, s38
  s_add_u32 s6, s6, s38
  s_mov_b32 s10, s39
  s_add_u32 s37, s37, 1
  s_mul_i32 s38, s37, 205
  s_lshr_b32 s38, s38, 10
  s_mul_i32 s39, s38, 5
  s_sub_u32 s39, s37, s39
  s_lshl_b32 s38, s38, 1
  s_cmp_ge_u32 s39, 3
  s_addc_u32 s38, s38, 0
  s_mul_i32 s7, s38, s36
  s_cmp_eq_u32 s39, 1
  s_cselect_b32 s38, 512, 0
  s_cmp_eq_u32 s39, 4
  s_cselect_b32 s38, 512, s38
  s_add_u32 s7, s7, s38
  s_mov_b32 s11, s39
  s_add_u32 s37, s37, 1
  s_waitcnt vmcnt(0) lgkmcnt(0)
  s_add_u32 s54, s54, 1
  v_lshlrev_b32 v130, 16, v120
  v_and_b32 v131, 0xffff0000, v120
  v_add_f32 v128, v130, v131
  v_mul_f32 v129, v130, v130
  v_fmac_f32 v129, v131, v131
  v_lshlrev_b32 v130, 16, v121
  v_and_b32 v131, 0xffff0000, v121
  v_add_f32 v128, v128, v130
  v_fmac_f32 v129, v130, v130
  v_add_f32 v128, v128, v131
  v_fmac_f32 v129, v131, v131
  v_lshlrev_b32 v130, 16, v122
  v_and_b32 v131, 0xffff0000, v122
  v_add_f32 v128, v128, v130
  v_fmac_f32 v129, v130, v130
  v_add_f32 v128, v128, v131
  v_fmac_f32 v129, v131, v131
  v_lshlrev_b32 v130, 16, v123
  v_and_b32 v131, 0xffff0000, v123
  v_add_f32 v128, v128, v130
  v_fmac_f32 v129, v130, v130
  v_add_f32 v128, v128, v131
  v_fmac_f32 v129, v131, v131
  v_lshlrev_b32 v130, 16, v124
  v_and_b32 v131, 0xffff0000, v124
  v_add_f32 v128, v128, v130
  v_fmac_f32 v129, v130, v130
  v_add_f32 v128, v128, v131
  v_fmac_f32 v129, v131, v131
  v_lshlrev_b32 v130, 16, v125
  v_and_b32 v131, 0xffff0000, v125
  v_add_f32 v128, v128, v130
  v_fmac_f32 v129, v130, v130
  v_add_f32 v128, v128, v131
  v_fmac_f32 v129, v131, v131
  v_lshlrev_b32 v130, 16, v126
  v_and_b32 v131, 0xffff0000, v126
  v_add_f32 v128, v128, v130
  v_fmac_f32 v129, v130, v130
  v_add_f32 v128, v128, v131
  v_fmac_f32 v129, v131, v131
  v_lshlrev_b32 v130, 16, v127
  v_and_b32 v131, 0xffff0000, v127
  v_add_f32 v128, v128, v130
  v_fmac_f32 v129, v130, v130
  v_add_f32 v128, v128, v131
  v_fmac_f32 v129, v131, v131
  s_nop 1
  v_add_f32_dpp v128, v128, v128 quad_perm:[1,0,3,2] row_mask:0xf bank_mask:0xf
  v_add_f32_dpp v129, v129, v129 quad_perm:[1,0,3,2] row_mask:0xf bank_mask:0xf
  s_nop 1
  v_add_f32_dpp v128, v128, v128 quad_perm:[2,3,0,1] row_mask:0xf bank_mask:0xf
  v_add_f32_dpp v129, v129, v129 quad_perm:[2,3,0,1] row_mask:0xf bank_mask:0xf
  s_nop 1
  v_add_f32_dpp v128, v128, v128 row_half_mirror row_mask:0xf bank_mask:0xf
  v_add_f32_dpp v129, v129, v129 row_half_mirror row_mask:0xf bank_mask:0xf
  s_nop 1
  v_add_f32_dpp v128, v128, v128 row_mirror row_mask:0xf bank_mask:0xf
  v_add_f32_dpp v129, v129, v129 row_mirror row_mask:0xf bank_mask:0xf
  v_mov_b32 v130, v128
  v_mov_b32 v131, v129
  s_nop 1
  v_permlane16_swap_b32 v128, v130
  v_permlane16_swap_b32 v129, v131
  v_add_f32 v128, v128, v130
  v_add_f32 v129, v129, v131
  v_mov_b32 v130, v128
  v_mov_b32 v131, v129
  s_nop 1
  v_permlane32_swap_b32 v128, v130
  v_permlane32_swap_b32 v129, v131
  v_add_f32 v128, v128, v130
  v_add_f32 v129, v129, v131
  v_mul_f32 v128, 0x3acccccd, v128
  v_mul_f32 v129, 0x3acccccd, v129
  v_fma_f32 v129, -v128, v128, v129
  v_max_f32 v129, 0, v129
  v_add_f32 v129, 0x3727c5ac, v129
  v_rsq_f32 v120, v129
  v_mov_b32 v121, s54
  v_mov_b32 v123, s54
  s_lshl_b32 s34, s27, 4
  s_add_u32 s34, s34, 23887872
  v_mul_f32 v122, -v128, v120
  v_mov_b32 v3, 0
  s_mov_b64 exec, 1
  buffer_store_dwordx4 v[120:123], v3, s[12:15], s34 offen sc1
  s_mov_b64 exec, -1
  s_lshr_b32 s34, s16, 1
  s_lshl_b32 s34, s34, 8
  s_and_b32 s35, s16, 1
  s_lshl_b32 s35, s35, 5
  s_add_u32 s34, s34, s35
  s_add_u32 s34, s34, 135168
  v_lshrrev_b32 v3, 4, v0
  v_lshlrev_b32 v3, 11, v3
  v_bfe_u32 v4, v0, 2, 2
  v_lshl_add_u32 v3, v4, 6, v3
  v_and_b32 v4, 3, v0
  v_lshl_add_u32 v3, v4, 3, v3
  v_add_u32 v116, s34, v3
  v_mov_b32 v108, 0x3f803f80
  v_mov_b32 v109, 0x3f803f80
  v_mov_b32 v110, 0x3f803f80
  v_mov_b32 v111, 0x3f803f80
  s_waitcnt lgkmcnt(0)
  s_barrier
  ds_read_b128 v[48:51], v11 offset:0
  ds_read_b128 v[52:55], v11 offset:4096
  ds_read_b64_tr_b16 v[64:65], v15 offset:0
  ds_read_b64_tr_b16 v[66:67], v15 offset:1024
  ds_read_b128 v[56:59], v12 offset:0
  ds_read_b128 v[60:63], v12 offset:4096
  ds_read_b64_tr_b16 v[68:69], v15 offset:4096
  ds_read_b64_tr_b16 v[70:71], v15 offset:5120
  s_movk_i32 s44, 16384
  v_add_u32 v11, s44, v6
  v_add_u32 v12, s44, v7
  s_branch KA_QL_1
.p2align 6
KA_QL:
  s_waitcnt lgkmcnt(0)
  s_barrier
  v_mfma_f32_32x32x16_bf16 v[16:31], v[88:91], v[72:75], v[16:31]
  ds_read_b128 v[48:51], v11 offset:0
  ds_read_b128 v[52:55], v11 offset:4096
  ds_read_b64_tr_b16 v[64:65], v15 offset:0
  ds_read_b64_tr_b16 v[66:67], v15 offset:1024
  v_mfma_f32_32x32x16_bf16 v[32:47], v[88:91], v[76:79], v[32:47]
  ds_read_b128 v[56:59], v12 offset:0
  ds_read_b128 v[60:63], v12 offset:4096
  ds_read_b64_tr_b16 v[68:69], v15 offset:4096
  ds_read_b64_tr_b16 v[70:71], v15 offset:5120
  v_mfma_f32_32x32x16_bf16 v[16:31], v[92:95], v[80:83], v[16:31]
  s_add_u32 s44, s44, 16384
  s_and_b32 s44, s44, 0xffff
  v_add_u32 v11, s44, v6
  v_add_u32 v12, s44, v7
  v_mfma_f32_32x32x16_bf16 v[32:47], v[92:95], v[84:87], v[32:47]
KA_QL_1:
  s_waitcnt lgkmcnt(0)
  v_mfma_f32_32x32x16_bf16 v[16:31], v[64:67], v[48:51], v[16:31]
  ds_read_b128 v[72:75], v13 offset:0
  ds_read_b128 v[76:79], v13 offset:4096
  ds_read_b64_tr_b16 v[88:89], v15 offset:8192
  ds_read_b64_tr_b16 v[90:91], v15 offset:9216
  v_mfma_f32_32x32x16_bf16 v[32:47], v[64:67], v[52:55], v[32:47]
  ds_read_b128 v[80:83], v14 offset:0
  ds_read_b128 v[84:87], v14 offset:4096
  ds_read_b64_tr_b16 v[92:93], v15 offset:12288
  ds_read_b64_tr_b16 v[94:95], v15 offset:13312
  v_mfma_f32_32x32x16_bf16 v[16:31], v[68:71], v[56:59], v[16:31]
  v_add_u32 v13, s44, v8
  v_add_u32 v14, s44, v9
  v_add_u32 v15, s44, v10
  v_mfma_f32_32x32x16_bf16 v[32:47], v[68:71], v[60:63], v[32:47]
  s_cmp_lg_u32 s45, 7
  s_cbranch_scc1 KA_QL_C
  ds_read_b64_tr_b16 v[100:101], v116 offset:0
  ds_read_b64_tr_b16 v[102:103], v116 offset:1024
  ds_read_b64_tr_b16 v[104:105], v116 offset:8192
  ds_read_b64_tr_b16 v[106:107], v116 offset:9216
  s_waitcnt lgkmcnt(0)
  v_mfma_f32_16x16x32_bf16 v[112:115], v[108:111], v[100:103], 0
  v_mfma_f32_16x16x32_bf16 v[112:115], v[108:111], v[104:107], v[112:115]
  s_lshl_b32 s34, s18, 4
  s_add_u32 s34, s34, s17
  s_lshl_b32 s34, s34, 3
  s_add_u32 s34, s34, s16
  s_lshl_b32 s34, s34, 7
  s_add_u32 s34, s34, 24641536
  v_lshlrev_b32 v3, 3, v0
  s_nop 0
  v_mov_b32 v113, s54
  s_mov_b64 exec, 0xffff
  buffer_store_dwordx2 v[112:113], v3, s[12:15], s34 offen sc1
  s_mov_b64 exec, -1
KA_QL_C:
  s_sub_u32 s45, s45, 1
  s_cmp_lg_u32 s45, 0
  s_cbranch_scc1 KA_QL
  s_lshl_b32 s36, s33, 7
  s_add_u32 s36, s36, 132096
  v_lshl_add_u32 v3, v2, 4, s36
  s_lshl_b32 s36, s32, 8
  s_add_u32 s36, s36, 131072
  v_lshl_add_u32 v4, v1, 2, s36
  ds_read_b32 v116, v4 offset:0
  ds_read_b32 v118, v4 offset:512
  ds_read_b32 v120, v4 offset:128
  ds_read_b32 v122, v4 offset:640
  ds_read_b128 v[100:103], v3 offset:0
  ds_read_b128 v[104:107], v3 offset:32
  ds_read_b128 v[108:111], v3 offset:64
  ds_read_b128 v[112:115], v3 offset:96
  s_waitcnt lgkmcnt(8)
  v_mfma_f32_32x32x16_bf16 v[16:31], v[88:91], v[72:75], v[16:31]
  v_mfma_f32_32x32x16_bf16 v[32:47], v[88:91], v[76:79], v[32:47]
  v_mfma_f32_32x32x16_bf16 v[16:31], v[92:95], v[80:83], v[16:31]
  v_mfma_f32_32x32x16_bf16 v[32:47], v[92:95], v[84:87], v[32:47]
  s_cmp_eq_u32 s19, 0
  s_cselect_b32 s37, 0x3ea52b5c, 1.0
  s_waitcnt lgkmcnt(4)
  v_mul_f32 v116, s37, v116
  v_mul_f32 v118, s37, v118
  v_mul_f32 v120, s37, v120
  v_mul_f32 v122, s37, v122
  s_nop 3
  s_waitcnt lgkmcnt(3)
  v_pk_mul_f32 v[48:49], v[100:101], v[118:119] op_sel_hi:[1,0]
  v_pk_mul_f32 v[50:51], v[102:103], v[118:119] op_sel_hi:[1,0]
  v_pk_fma_f32 v[48:49], v[16:17], v[116:117], v[48:49] op_sel_hi:[1,0,1]
  v_pk_fma_f32 v[50:51], v[18:19], v[116:117], v[50:51] op_sel_hi:[1,0,1]
  v_cvt_pk_bf16_f32 v56, v48, v49
  v_cvt_pk_bf16_f32 v57, v50, v51
  v_pk_mul_f32 v[52:53], v[100:101], v[122:123] op_sel_hi:[1,0]
  v_pk_mul_f32 v[54:55], v[102:103], v[122:123] op_sel_hi:[1,0]
  v_pk_fma_f32 v[52:53], v[32:33], v[120:121], v[52:53] op_sel_hi:[1,0,1]
  v_pk_fma_f32 v[54:55], v[34:35], v[120:121], v[54:55] op_sel_hi:[1,0,1]
  v_cvt_pk_bf16_f32 v58, v52, v53
  v_cvt_pk_bf16_f32 v59, v54, v55
  s_cmp_eq_u32 s8, 2
  s_cbranch_scc1 KA_N_3
  v_permlane32_swap_b32 v56, v58
  v_permlane32_swap_b32 v57, v59
  buffer_store_dwordx4 v[56:59], v96, s[12:15], s4 offen sc1
  s_branch KA_D_4
KA_N_3:
  buffer_store_dwordx2 v[56:57], v97, s[12:15], s4 offen sc1
  buffer_store_dwordx2 v[58:59], v97, s[12:15], s4 offen offset:256 sc1
KA_D_4:
  s_waitcnt lgkmcnt(2)
  v_pk_mul_f32 v[48:49], v[104:105], v[118:119] op_sel_hi:[1,0]
  v_pk_mul_f32 v[50:51], v[106:107], v[118:119] op_sel_hi:[1,0]
  v_pk_fma_f32 v[48:49], v[20:21], v[116:117], v[48:49] op_sel_hi:[1,0,1]
  v_pk_fma_f32 v[50:51], v[22:23], v[116:117], v[50:51] op_sel_hi:[1,0,1]
  v_cvt_pk_bf16_f32 v60, v48, v49
  v_cvt_pk_bf16_f32 v61, v50, v51
  v_pk_mul_f32 v[52:53], v[104:105], v[122:123] op_sel_hi:[1,0]
  v_pk_mul_f32 v[54:55], v[106:107], v[122:123] op_sel_hi:[1,0]
  v_pk_fma_f32 v[52:53], v[36:37], v[120:121], v[52:53] op_sel_hi:[1,0,1]
  v_pk_fma_f32 v[54:55], v[38:39], v[120:121], v[54:55] op_sel_hi:[1,0,1]
  v_cvt_pk_bf16_f32 v62, v52, v53
  v_cvt_pk_bf16_f32 v63, v54, v55
  s_cmp_eq_u32 s9, 2
  s_cbranch_scc1 KA_N_5
  v_permlane32_swap_b32 v60, v62
  v_permlane32_swap_b32 v61, v63
  buffer_store_dwordx4 v[60:63], v96, s[12:15], s5 offen sc1
  s_branch KA_D_6
KA_N_5:
  buffer_store_dwordx2 v[60:61], v97, s[12:15], s5 offen sc1
  buffer_store_dwordx2 v[62:63], v97, s[12:15], s5 offen offset:256 sc1
KA_D_6:
  s_waitcnt lgkmcnt(1)
  v_pk_mul_f32 v[48:49], v[108:109], v[118:119] op_sel_hi:[1,0]
  v_pk_mul_f32 v[50:51], v[110:111], v[118:119] op_sel_hi:[1,0]
  v_pk_fma_f32 v[48:49], v[24:25], v[116:117], v[48:49] op_sel_hi:[1,0,1]
  v_pk_fma_f32 v[50:51], v[26:27], v[116:117], v[50:51] op_sel_hi:[1,0,1]
  v_cvt_pk_bf16_f32 v56, v48, v49
  v_cvt_pk_bf16_f32 v57, v50, v51
  v_pk_mul_f32 v[52:53], v[108:109], v[122:123] op_sel_hi:[1,0]
  v_pk_mul_f32 v[54:55], v[110:111], v[122:123] op_sel_hi:[1,0]
  v_pk_fma_f32 v[52:53], v[40:41], v[120:121], v[52:53] op_sel_hi:[1,0,1]
  v_pk_fma_f32 v[54:55], v[42:43], v[120:121], v[54:55] op_sel_hi:[1,0,1]
  v_cvt_pk_bf16_f32 v58, v52, v53
  v_cvt_pk_bf16_f32 v59, v54, v55
  s_cmp_eq_u32 s10, 2
  s_cbranch_scc1 KA_N_7
  v_permlane32_swap_b32 v56, v58
  v_permlane32_swap_b32 v57, v59
  buffer_store_dwordx4 v[56:59], v96, s[12:15], s6 offen sc1
  s_branch KA_D_8
KA_N_7:
  buffer_store_dwordx2 v[56:57], v97, s[12:15], s6 offen sc1
  buffer_store_dwordx2 v[58:59], v97, s[12:15], s6 offen offset:256 sc1
KA_D_8:
  s_waitcnt lgkmcnt(0)
  v_pk_mul_f32 v[48:49], v[112:113], v[118:119] op_sel_hi:[1,0]
  v_pk_mul_f32 v[50:51], v[114:115], v[118:119] op_sel_hi:[1,0]
  v_pk_fma_f32 v[48:49], v[28:29], v[116:117], v[48:49] op_sel_hi:[1,0,1]
  v_pk_fma_f32 v[50:51], v[30:31], v[116:117], v[50:51] op_sel_hi:[1,0,1]
  v_cvt_pk_bf16_f32 v60, v48, v49
  v_cvt_pk_bf16_f32 v61, v50, v51
  v_pk_mul_f32 v[52:53], v[112:113], v[122:123] op_sel_hi:[1,0]
  v_pk_mul_f32 v[54:55], v[114:115], v[122:123] op_sel_hi:[1,0]
  v_pk_fma_f32 v[52:53], v[44:45], v[120:121], v[52:53] op_sel_hi:[1,0,1]
  v_pk_fma_f32 v[54:55], v[46:47], v[120:121], v[54:55] op_sel_hi:[1,0,1]
  v_cvt_pk_bf16_f32 v62, v52, v53
  v_cvt_pk_bf16_f32 v63, v54, v55
  s_cmp_eq_u32 s11, 2
  s_cbranch_scc1 KA_N_9
  v_permlane32_swap_b32 v60, v62
  v_permlane32_swap_b32 v61, v63
  buffer_store_dwordx4 v[60:63], v96, s[12:15], s7 offen sc1
  s_branch KA_D_10
KA_N_9:
  buffer_store_dwordx2 v[60:61], v97, s[12:15], s7 offen sc1
  buffer_store_dwordx2 v[62:63], v97, s[12:15], s7 offen offset:256 sc1
KA_D_10:
  s_branch KA_PUB
KA_V:
  s_mul_i32 s36, s17, 10240
  s_add_u32 s36, s36, 3150848
  s_mul_i32 s37, s32, 2560
  s_add_u32 s37, s37, s36
  s_lshl_b32 s38, s26, 7
  s_lshl_b32 s39, s33, 5
  s_add_u32 s39, s39, s38
  s_mov_b32 s40, 163840
  v_lshl_add_u32 v100, v2, 4, s37
  v_add_u32 v101, s39, v1
  v_mul_u32_u24 v102, 3277, v101
  v_lshrrev_b32 v102, 16, v102
  v_mul_u32_u24 v103, 20, v102
  v_sub_u32 v101, v101, v103
  v_and_b32 v103, 1, v102
  v_lshl_add_u32 v101, v103, 4, v101
  v_subrev_u32 v103, 20, v101
  v_min_u32 v101, v101, v103
  v_lshl_add_u32 v101, v101, 5, v100
  v_mad_u32_u24 v96, v102, s40, v101
  s_waitcnt vmcnt(0) lgkmcnt(0)
  s_add_u32 s54, s54, 1
  v_lshlrev_b32 v130, 16, v120
  v_and_b32 v131, 0xffff0000, v120
  v_add_f32 v128, v130, v131
  v_mul_f32 v129, v130, v130
  v_fmac_f32 v129, v131, v131
  v_lshlrev_b32 v130, 16, v121
  v_and_b32 v131, 0xffff0000, v121
  v_add_f32 v128, v128, v130
  v_fmac_f32 v129, v130, v130
  v_add_f32 v128, v128, v131
  v_fmac_f32 v129, v131, v131
  v_lshlrev_b32 v130, 16, v122
  v_and_b32 v131, 0xffff0000, v122
  v_add_f32 v128, v128, v130
  v_fmac_f32 v129, v130, v130
  v_add_f32 v128, v128, v131
  v_fmac_f32 v129, v131, v131
  v_lshlrev_b32 v130, 16, v123
  v_and_b32 v131, 0xffff0000, v123
  v_add_f32 v128, v128, v130
  v_fmac_f32 v129, v130, v130
  v_add_f32 v128, v128, v131
  v_fmac_f32 v129, v131, v131
  v_lshlrev_b32 v130, 16, v124
  v_and_b32 v131, 0xffff0000, v124
  v_add_f32 v128, v128, v130
  v_fmac_f32 v129, v130, v130
  v_add_f32 v128, v128, v131
  v_fmac_f32 v129, v131, v131
  v_lshlrev_b32 v130, 16, v125
  v_and_b32 v131, 0xffff0000, v125
  v_add_f32 v128, v128, v130
  v_fmac_f32 v129, v130, v130
  v_add_f32 v128, v128, v131
  v_fmac_f32 v129, v131, v131
  v_lshlrev_b32 v130, 16, v126
  v_and_b32 v131, 0xffff0000, v126
  v_add_f32 v128, v128, v130
  v_fmac_f32 v129, v130, v130
  v_add_f32 v128, v128, v131
  v_fmac_f32 v129, v131, v131
  v_lshlrev_b32 v130, 16, v127
  v_and_b32 v131, 0xffff0000, v127
  v_add_f32 v128, v128, v130
  v_fmac_f32 v129, v130, v130
  v_add_f32 v128, v128, v131
  v_fmac_f32 v129, v131, v131
  s_nop 1
  v_add_f32_dpp v128, v128, v128 quad_perm:[1,0,3,2] row_mask:0xf bank_mask:0xf
  v_add_f32_dpp v129, v129, v129 quad_perm:[1,0,3,2] row_mask:0xf bank_mask:0xf
  s_nop 1
  v_add_f32_dpp v128, v128, v128 quad_perm:[2,3,0,1] row_mask:0xf bank_mask:0xf
  v_add_f32_dpp v129, v129, v129 quad_perm:[2,3,0,1] row_mask:0xf bank_mask:0xf
  s_nop 1
  v_add_f32_dpp v128, v128, v128 row_half_mirror row_mask:0xf bank_mask:0xf
  v_add_f32_dpp v129, v129, v129 row_half_mirror row_mask:0xf bank_mask:0xf
  s_nop 1
  v_add_f32_dpp v128, v128, v128 row_mirror row_mask:0xf bank_mask:0xf
  v_add_f32_dpp v129, v129, v129 row_mirror row_mask:0xf bank_mask:0xf
  v_mov_b32 v130, v128
  v_mov_b32 v131, v129
  s_nop 1
  v_permlane16_swap_b32 v128, v130
  v_permlane16_swap_b32 v129, v131
  v_add_f32 v128, v128, v130
  v_add_f32 v129, v129, v131
  v_mov_b32 v130, v128
  v_mov_b32 v131, v129
  s_nop 1
  v_permlane32_swap_b32 v128, v130
  v_permlane32_swap_b32 v129, v131
  v_add_f32 v128, v128, v130
  v_add_f32 v129, v129, v131
  v_mul_f32 v128, 0x3acccccd, v128
  v_mul_f32 v129, 0x3acccccd, v129
  v_fma_f32 v129, -v128, v128, v129
  v_max_f32 v129, 0, v129
  v_add_f32 v129, 0x3727c5ac, v129
  v_rsq_f32 v120, v129
  v_mov_b32 v121, s54
  v_mov_b32 v123, s54
  s_lshl_b32 s34, s27, 4
  s_add_u32 s34, s34, 23887872
  v_mul_f32 v122, -v128, v120
  v_mov_b32 v3, 0
  s_mov_b64 exec, 1
  buffer_store_dwordx4 v[120:123], v3, s[12:15], s34 offen sc1
  s_mov_b64 exec, -1
  s_lshr_b32 s34, s16, 1
  s_lshl_b32 s34, s34, 8
  s_and_b32 s35, s16, 1
  s_lshl_b32 s35, s35, 5
  s_add_u32 s34, s34, s35
  s_add_u32 s34, s34, 135168
  v_lshrrev_b32 v3, 4, v0
  v_lshlrev_b32 v3, 11, v3
  v_bfe_u32 v4, v0, 2, 2
  v_lshl_add_u32 v3, v4, 6, v3
  v_and_b32 v4, 3, v0
  v_lshl_add_u32 v3, v4, 3, v3
  v_add_u32 v116, s34, v3
  v_mov_b32 v108, 0x3f803f80
  v_mov_b32 v109, 0x3f803f80
  v_mov_b32 v110, 0x3f803f80
  v_mov_b32 v111, 0x3f803f80
  s_waitcnt lgkmcnt(0)
  s_barrier
  ds_read_b128 v[48:51], v11 offset:0
  ds_read_b128 v[52:55], v11 offset:4096
  ds_read_b64_tr_b16 v[64:65], v15 offset:0
  ds_read_b64_tr_b16 v[66:67], v15 offset:1024
  ds_read_b128 v[56:59], v12 offset:0
  ds_read_b128 v[60:63], v12 offset:4096
  ds_read_b64_tr_b16 v[68:69], v15 offset:4096
  ds_read_b64_tr_b16 v[70:71], v15 offset:5120
  s_movk_i32 s44, 16384
  v_add_u32 v11, s44, v6
  v_add_u32 v12, s44, v7
  s_branch KA_VL_1
.p2align 6
KA_VL:
  s_waitcnt lgkmcnt(0)
  s_barrier
  v_mfma_f32_32x32x16_bf16 v[16:31], v[72:75], v[88:91], v[16:31]
  ds_read_b128 v[48:51], v11 offset:0
  ds_read_b128 v[52:55], v11 offset:4096
  ds_read_b64_tr_b16 v[64:65], v15 offset:0
  ds_read_b64_tr_b16 v[66:67], v15 offset:1024
  v_mfma_f32_32x32x16_bf16 v[32:47], v[76:79], v[88:91], v[32:47]
  ds_read_b128 v[56:59], v12 offset:0
  ds_read_b128 v[60:63], v12 offset:4096
  ds_read_b64_tr_b16 v[68:69], v15 offset:4096
  ds_read_b64_tr_b16 v[70:71], v15 offset:5120
  v_mfma_f32_32x32x16_bf16 v[16:31], v[80:83], v[92:95], v[16:31]
  s_add_u32 s44, s44, 16384
  s_and_b32 s44, s44, 0xffff
  v_add_u32 v11, s44, v6
  v_add_u32 v12, s44, v7
  v_mfma_f32_32x32x16_bf16 v[32:47], v[84:87], v[92:95], v[32:47]
KA_VL_1:
  s_waitcnt lgkmcnt(0)
  v_mfma_f32_32x32x16_bf16 v[16:31], v[48:51], v[64:67], v[16:31]
  ds_read_b128 v[72:75], v13 offset:0
  ds_read_b128 v[76:79], v13 offset:4096
  ds_read_b64_tr_b16 v[88:89], v15 offset:8192
  ds_read_b64_tr_b16 v[90:91], v15 offset:9216
  v_mfma_f32_32x32x16_bf16 v[32:47], v[52:55], v[64:67], v[32:47]
  ds_read_b128 v[80:83], v14 offset:0
  ds_read_b128 v[84:87], v14 offset:4096
  ds_read_b64_tr_b16 v[92:93], v15 offset:12288
  ds_read_b64_tr_b16 v[94:95], v15 offset:13312
  v_mfma_f32_32x32x16_bf16 v[16:31], v[56:59], v[68:71], v[16:31]
  v_add_u32 v13, s44, v8
  v_add_u32 v14, s44, v9
  v_add_u32 v15, s44, v10
  v_mfma_f32_32x32x16_bf16 v[32:47], v[60:63], v[68:71], v[32:47]
  s_cmp_lg_u32 s45, 7
  s_cbranch_scc1 KA_VL_C
  ds_read_b64_tr_b16 v[100:101], v116 offset:0
  ds_read_b64_tr_b16 v[102:103], v116 offset:1024
  ds_read_b64_tr_b16 v[104:105], v116 offset:8192
  ds_read_b64_tr_b16 v[106:107], v116 offset:9216
  s_waitcnt lgkmcnt(0)
  v_mfma_f32_16x16x32_bf16 v[112:115], v[108:111], v[100:103], 0
  v_mfma_f32_16x16x32_bf16 v[112:115], v[108:111], v[104:107], v[112:115]
  s_lshl_b32 s34, s18, 4
  s_add_u32 s34, s34, s17
  s_lshl_b32 s34, s34, 3
  s_add_u32 s34, s34, s16
  s_lshl_b32 s34, s34, 7
  s_add_u32 s34, s34, 24641536
  v_lshlrev_b32 v3, 3, v0
  s_nop 0
  v_mov_b32 v113, s54
  s_mov_b64 exec, 0xffff
  buffer_store_dwordx2 v[112:113], v3, s[12:15], s34 offen sc1
  s_mov_b64 exec, -1
KA_VL_C:
  s_sub_u32 s45, s45, 1
  s_cmp_lg_u32 s45, 0
  s_cbranch_scc1 KA_VL
  s_lshl_b32 s36, s32, 8
  s_add_u32 s36, s36, 131072
  v_lshl_add_u32 v3, v2, 4, s36
  s_lshl_b32 s36, s33, 7
  s_add_u32 s36, s36, 132096
  v_lshl_add_u32 v4, v1, 2, s36
  s_waitcnt lgkmcnt(0)
  ds_read_b32 v98, v4
  v_mfma_f32_32x32x16_bf16 v[16:31], v[72:75], v[88:91], v[16:31]
  ds_read_b128 v[100:103], v3 offset:0
  ds_read_b128 v[104:107], v3 offset:512
  ds_read_b128 v[108:111], v3 offset:32
  ds_read_b128 v[112:115], v3 offset:544
  v_mfma_f32_32x32x16_bf16 v[32:47], v[76:79], v[88:91], v[32:47]
  ds_read_b128 v[116:119], v3 offset:64
  ds_read_b128 v[120:123], v3 offset:576
  ds_read_b128 v[124:127], v3 offset:96
  ds_read_b128 v[128:131], v3 offset:608
  v_mfma_f32_32x32x16_bf16 v[16:31], v[80:83], v[92:95], v[16:31]
  ds_read_b128 v[48:51], v3 offset:128
  ds_read_b128 v[52:55], v3 offset:640
  ds_read_b128 v[56:59], v3 offset:160
  ds_read_b128 v[60:63], v3 offset:672
  v_mfma_f32_32x32x16_bf16 v[32:47], v[84:87], v[92:95], v[32:47]
  ds_read_b128 v[64:67], v3 offset:192
  ds_read_b128 v[68:71], v3 offset:704
  ds_read_b128 v[132:135], v3 offset:224
  ds_read_b128 v[136:139], v3 offset:736
  s_nop 7
  s_waitcnt lgkmcnt(12)
  v_pk_mul_f32 v[80:81], v[104:105], v[98:99] op_sel_hi:[1,0]
  v_pk_mul_f32 v[82:83], v[106:107], v[98:99] op_sel_hi:[1,0]
  v_pk_mul_f32 v[84:85], v[112:113], v[98:99] op_sel_hi:[1,0]
  v_pk_mul_f32 v[86:87], v[114:115], v[98:99] op_sel_hi:[1,0]
  v_pk_fma_f32 v[80:81], v[16:17], v[100:101], v[80:81]
  v_pk_fma_f32 v[82:83], v[18:19], v[102:103], v[82:83]
  v_pk_fma_f32 v[84:85], v[20:21], v[108:109], v[84:85]
  v_pk_fma_f32 v[86:87], v[22:23], v[110:111], v[86:87]
  v_cvt_pk_bf16_f32 v88, v80, v81
  v_cvt_pk_bf16_f32 v89, v82, v83
  v_cvt_pk_bf16_f32 v90, v84, v85
  v_cvt_pk_bf16_f32 v91, v86, v87
  buffer_store_dwordx4 v[88:91], v96, s[12:15], 0 offen offset:0 sc1
  s_waitcnt lgkmcnt(8)
  v_pk_mul_f32 v[80:81], v[120:121], v[98:99] op_sel_hi:[1,0]
  v_pk_mul_f32 v[82:83], v[122:123], v[98:99] op_sel_hi:[1,0]
  v_pk_mul_f32 v[84:85], v[128:129], v[98:99] op_sel_hi:[1,0]
  v_pk_mul_f32 v[86:87], v[130:131], v[98:99] op_sel_hi:[1,0]
  v_pk_fma_f32 v[80:81], v[24:25], v[116:117], v[80:81]
  v_pk_fma_f32 v[82:83], v[26:27], v[118:119], v[82:83]
  v_pk_fma_f32 v[84:85], v[28:29], v[124:125], v[84:85]
  v_pk_fma_f32 v[86:87], v[30:31], v[126:127], v[86:87]
  v_cvt_pk_bf16_f32 v92, v80, v81
  v_cvt_pk_bf16_f32 v93, v82, v83
  v_cvt_pk_bf16_f32 v94, v84, v85
  v_cvt_pk_bf16_f32 v95, v86, v87
  buffer_store_dwordx4 v[92:95], v96, s[12:15], 0 offen offset:640 sc1
  s_waitcnt lgkmcnt(4)
  v_pk_mul_f32 v[80:81], v[52:53], v[98:99] op_sel_hi:[1,0]
  v_pk_mul_f32 v[82:83], v[54:55], v[98:99] op_sel_hi:[1,0]
  v_pk_mul_f32 v[84:85], v[60:61], v[98:99] op_sel_hi:[1,0]
  v_pk_mul_f32 v[86:87], v[62:63], v[98:99] op_sel_hi:[1,0]
  v_pk_fma_f32 v[80:81], v[32:33], v[48:49], v[80:81]
  v_pk_fma_f32 v[82:83], v[34:35], v[50:51], v[82:83]
  v_pk_fma_f32 v[84:85], v[36:37], v[56:57], v[84:85]
  v_pk_fma_f32 v[86:87], v[38:39], v[58:59], v[86:87]
  v_cvt_pk_bf16_f32 v88, v80, v81
  v_cvt_pk_bf16_f32 v89, v82, v83
  v_cvt_pk_bf16_f32 v90, v84, v85
  v_cvt_pk_bf16_f32 v91, v86, v87
  buffer_store_dwordx4 v[88:91], v96, s[12:15], 0 offen offset:1280 sc1
  s_waitcnt lgkmcnt(0)
  v_pk_mul_f32 v[80:81], v[68:69], v[98:99] op_sel_hi:[1,0]
  v_pk_mul_f32 v[82:83], v[70:71], v[98:99] op_sel_hi:[1,0]
  v_pk_mul_f32 v[84:85], v[136:137], v[98:99] op_sel_hi:[1,0]
  v_pk_mul_f32 v[86:87], v[138:139], v[98:99] op_sel_hi:[1,0]
  v_pk_fma_f32 v[80:81], v[40:41], v[64:65], v[80:81]
  v_pk_fma_f32 v[82:83], v[42:43], v[66:67], v[82:83]
  v_pk_fma_f32 v[84:85], v[44:45], v[132:133], v[84:85]
  v_pk_fma_f32 v[86:87], v[46:47], v[134:135], v[86:87]
  v_cvt_pk_bf16_f32 v92, v80, v81
  v_cvt_pk_bf16_f32 v93, v82, v83
  v_cvt_pk_bf16_f32 v94, v84, v85
  v_cvt_pk_bf16_f32 v95, v86, v87
  buffer_store_dwordx4 v[92:95], v96, s[12:15], 0 offen offset:1920 sc1
KA_PUB:
  s_lshl_b32 s34, s18, 4
  s_add_u32 s34, s34, s17
  s_lshl_b32 s34, s34, 7
  s_add_u32 s55, s34, 23822336
  s_branch K2_COMP
KA_SPARE:
  s_cmp_lt_u32 s16, 8
  s_cbranch_scc1 KA_S1
  s_sub_u32 s16, s16, 8
  s_branch K2_LOAD
KA_S1:
  s_waitcnt lgkmcnt(0)
  s_mov_b32 s12, s24
  s_mov_b32 s13, s25
  s_mov_b32 s14, 34603008
  s_mov_b32 s15, 0x20000
  s_mov_b32 s4, s20
  s_mov_b32 s5, s21
  s_mov_b32 s6, 2621440
  s_mov_b32 s7, 0x20000
  s_add_u32 s54, s24, 23863296
  s_addc_u32 s55, s25, 0
  s_load_dword s54, s[54:55], 0
  s_bfe_u32 s27, s2, 0x30000
  s_lshl_b32 s27, s27, 5
  s_lshr_b32 s34, s2, 3
  s_add_u32 s27, s27, s34
  s_lshl_b32 s27, s27, 3
  s_add_u32 s27, s27, s16
  s_mul_i32 s34, s27, 1280
  v_lshlrev_b32 v1, 4, v0
  v_lshrrev_b32 v2, 4, v0
  v_lshl_add_u32 v2, v2, 24, v1
  buffer_load_dwordx4 v[8:11], v1, s[4:7], s34 offen
  buffer_load_dwordx4 v[12:15], v2, s[4:7], s34 offen offset:1024
  s_waitcnt vmcnt(0) lgkmcnt(0)
  s_add_u32 s54, s54, 1
  v_lshlrev_b32 v18, 16, v8
  v_and_b32 v19, 0xffff0000, v8
  v_add_f32 v16, v18, v19
  v_mul_f32 v17, v18, v18
  v_fmac_f32 v17, v19, v19
  v_lshlrev_b32 v18, 16, v9
  v_and_b32 v19, 0xffff0000, v9
  v_add_f32 v16, v16, v18
  v_fmac_f32 v17, v18, v18
  v_add_f32 v16, v16, v19
  v_fmac_f32 v17, v19, v19
  v_lshlrev_b32 v18, 16, v10
  v_and_b32 v19, 0xffff0000, v10
  v_add_f32 v16, v16, v18
  v_fmac_f32 v17, v18, v18
  v_add_f32 v16, v16, v19
  v_fmac_f32 v17, v19, v19
  v_lshlrev_b32 v18, 16, v11
  v_and_b32 v19, 0xffff0000, v11
  v_add_f32 v16, v16, v18
  v_fmac_f32 v17, v18, v18
  v_add_f32 v16, v16, v19
  v_fmac_f32 v17, v19, v19
  v_lshlrev_b32 v18, 16, v12
  v_and_b32 v19, 0xffff0000, v12
  v_add_f32 v16, v16, v18
  v_fmac_f32 v17, v18, v18
  v_add_f32 v16, v16, v19
  v_fmac_f32 v17, v19, v19
  v_lshlrev_b32 v18, 16, v13
  v_and_b32 v19, 0xffff0000, v13
  v_add_f32 v16, v16, v18
  v_fmac_f32 v17, v18, v18
  v_add_f32 v16, v16, v19
  v_fmac_f32 v17, v19, v19
  v_lshlrev_b32 v18, 16, v14
  v_and_b32 v19, 0xffff0000, v14
  v_add_f32 v16, v16, v18
  v_fmac_f32 v17, v18, v18
  v_add_f32 v16, v16, v19
  v_fmac_f32 v17, v19, v19
  v_lshlrev_b32 v18, 16, v15
  v_and_b32 v19, 0xffff0000, v15
  v_add_f32 v16, v16, v18
  v_fmac_f32 v17, v18, v18
  v_add_f32 v16, v16, v19
  v_fmac_f32 v17, v19, v19
  s_nop 1
  v_add_f32_dpp v16, v16, v16 quad_perm:[1,0,3,2] row_mask:0xf bank_mask:0xf
  v_add_f32_dpp v17, v17, v17 quad_perm:[1,0,3,2] row_mask:0xf bank_mask:0xf
  s_nop 1
  v_add_f32_dpp v16, v16, v16 quad_perm:[2,3,0,1] row_mask:0xf bank_mask:0xf
  v_add_f32_dpp v17, v17, v17 quad_perm:[2,3,0,1] row_mask:0xf bank_mask:0xf
  s_nop 1
  v_add_f32_dpp v16, v16, v16 row_half_mirror row_mask:0xf bank_mask:0xf
  v_add_f32_dpp v17, v17, v17 row_half_mirror row_mask:0xf bank_mask:0xf
  s_nop 1
  v_add_f32_dpp v16, v16, v16 row_mirror row_mask:0xf bank_mask:0xf
  v_add_f32_dpp v17, v17, v17 row_mirror row_mask:0xf bank_mask:0xf
  v_mov_b32 v18, v16
  v_mov_b32 v19, v17
  s_nop 1
  v_permlane16_swap_b32 v16, v18
  v_permlane16_swap_b32 v17, v19
  v_add_f32 v16, v16, v18
  v_add_f32 v17, v17, v19
  v_mov_b32 v18, v16
  v_mov_b32 v19, v17
  s_nop 1
  v_permlane32_swap_b32 v16, v18
  v_permlane32_swap_b32 v17, v19
  v_add_f32 v16, v16, v18
  v_add_f32 v17, v17, v19
  v_mul_f32 v16, 0x3acccccd, v16
  v_mul_f32 v17, 0x3acccccd, v17
  v_fma_f32 v17, -v16, v16, v17
  v_max_f32 v17, 0, v17
  v_add_f32 v17, 0x3727c5ac, v17
  v_rsq_f32 v8, v17
  v_mov_b32 v9, s54
  v_mov_b32 v11, s54
  s_lshl_b32 s34, s27, 4
  s_add_u32 s34, s34, 23887872
  v_mul_f32 v10, -v16, v8
  v_mov_b32 v1, 0
  s_mov_b64 exec, 1
  buffer_store_dwordx4 v[8:11], v1, s[12:15], s34 offen sc1
  s_mov_b64 exec, -1
  s_mov_b32 s55, 23853056
  s_branch K2_COMP
.p2align 6
K2_LOAD:
  s_setprio 3
  s_load_dwordx2 s[22:23], s[0:1], 16
  s_load_dwordx4 s[28:31], s[0:1], 40
  s_load_dwordx2 s[26:27], s[0:1], 32
  s_load_dwordx2 s[46:47], s[0:1], 56
  s_and_b32 s17, s2, 7
  s_lshl_b32 s17, s17, 2
  s_bfe_u32 s18, s2, 0x20003
  s_add_u32 s17, s17, s18
  s_lshr_b32 s18, s2, 5
  s_bfe_u32 s40, s2, 0x20001
  s_lshl_b32 s40, s40, 3
  s_bfe_u32 s41, s2, 0x30003
  s_add_u32 s40, s40, s41
  s_bfe_u32 s43, s2, 0x10002
  s_lshl_b32 s43, s43, 3
  s_add_u32 s43, s43, s41
  s_and_b32 s41, s2, 1
  s_lshl_b32 s41, s41, 2
  s_lshr_b32 s42, s2, 6
  s_add_u32 s41, s41, s42
  s_and_b32 s44, s2, 3
  s_lshl_b32 s44, s44, 2
  s_add_u32 s44, s44, s42
  s_mov_b32 s3, s44
  s_mul_i32 s44, s44, 3
  s_min_u32 s44, s44, 41
  s_add_u32 s44, s44, 64
  s_mul_i32 s42, s41, 160
  s_and_b32 s42, s42, 0xffc0
  v_lshlrev_b32_e64 v1, 4, v0
  s_mul_i32 s32, s17, 163840
  s_lshr_b32 s33, s16, 1
  s_mul_i32 s34, s33, 81920
  s_add_u32 s32, s32, s34
  s_and_b32 s34, s16, 1
  s_mul_i32 s34, s34, 5120
  s_add_u32 s32, s32, s34
  s_add_u32 s32, s32, 3145728
  s_mul_i32 s33, s16, 5120
  s_add_u32 s33, s33, 102400
  s_waitcnt lgkmcnt(0)
  s_mov_b32 s12, s24
  s_mov_b32 s13, s25
  s_mov_b32 s14, 34603008
  s_mov_b32 s15, 0x20000
  s_add_u32 s54, s24, 23863296
  s_addc_u32 s55, s25, 0
  s_load_dword s54, s[54:55], 0
  s_mul_i32 s35, s16, 2
  s_min_u32 s34, s16, 2
  s_add_u32 s35, s35, s34
  s_lshl_b32 s35, s35, 10
  s_mul_i32 s36, s41, 378880
  s_add_u32 s36, s36, s35
  s_add_u32 s36, s36, 30408704
  s_cmp_lt_u32 s2, 54
  s_cbranch_scc0 RT_D
  s_cmp_ge_u32 s2, 27
  s_cselect_b32 s8, s28, s26
  s_cselect_b32 s9, s29, s27
  s_cselect_b32 s34, 27, 0
  s_cselect_b32 s96, 1024, 0
  s_sub_u32 s34, s2, s34
  s_mov_b32 s10, 2211840
  s_mov_b32 s53, s10
  s_mov_b32 s100, 34603008
  s_mov_b32 s50, s100
  s_mov_b32 s101, 3456
  s_mov_b32 s52, 110592
  s_mul_i32 s47, s16, 552960
  s_lshl_b32 s37, s34, 7
  s_add_u32 s47, s47, s37
  s_lshl_b32 s34, s34, 13
  s_add_u32 s96, s96, s34
  s_mul_i32 s34, s16, 1105920
  s_add_u32 s96, s96, s34
  s_add_u32 s96, s96, 25165824
  s_add_u32 s97, s96, 2048
  s_add_u32 s98, s96, 4096
  s_add_u32 s99, s96, 6144
  s_mov_b32 s95, 2146435072
  s_branch RT_E
RT_D:
  s_sub_u32 s34, s2, 54
  s_lshl_b32 s34, s34, 2
  s_add_u32 s34, s34, s16
  s_lshl_b32 s95, s34, 2
  s_add_u32 s95, s95, 23867392
  s_cmp_lt_u32 s34, 740
  s_cselect_b32 s10, 2211840, 0
  s_cselect_b32 s50, 34603008, 0
  s_cmp_lt_u32 s34, 200
  s_cselect_b32 s8, s22, s30
  s_cselect_b32 s9, s23, s31
  s_cselect_b32 s10, 819200, s10
  s_cselect_b32 s95, s95, 2146435072
  s_cselect_b32 s53, 0, 819200
  s_mov_b32 s100, 0
  s_mov_b32 s101, 1280
  s_mov_b32 s52, 0
  s_mul_i32 s37, s34, 6554
  s_lshr_b32 s37, s37, 16
  s_mul_i32 s38, s37, 10
  s_sub_u32 s38, s34, s38
  s_mul_i32 s47, s37, 40960
  s_sub_u32 s47, s47, s53
  s_mov_b32 s53, 0
  s_lshl_b32 s34, s38, 7
  s_add_u32 s47, s47, s34
  s_mul_i32 s37, s37, 5120
  s_add_u32 s37, s37, 30408704
  s_lshl_b32 s38, s38, 2
  s_mul_i32 s34, s38, 205
  s_lshr_b32 s34, s34, 10
  s_mul_i32 s34, s34, 373760
  s_lshl_b32 s96, s38, 10
  s_add_u32 s96, s96, s34
  s_add_u32 s96, s96, s37
  s_add_u32 s38, s38, 1
  s_mul_i32 s34, s38, 205
  s_lshr_b32 s34, s34, 10
  s_mul_i32 s34, s34, 373760
  s_lshl_b32 s97, s38, 10
  s_add_u32 s97, s97, s34
  s_add_u32 s97, s97, s37
  s_add_u32 s38, s38, 1
  s_mul_i32 s34, s38, 205
  s_lshr_b32 s34, s34, 10
  s_mul_i32 s34, s34, 373760
  s_lshl_b32 s98, s38, 10
  s_add_u32 s98, s98, s34
  s_add_u32 s98, s98, s37
  s_add_u32 s38, s38, 1
  s_mul_i32 s34, s38, 205
  s_lshr_b32 s34, s34, 10
  s_mul_i32 s34, s34, 373760
  s_lshl_b32 s99, s38, 10
  s_add_u32 s99, s99, s34
  s_add_u32 s99, s99, s37
  s_add_u32 s38, s38, 1
RT_E:
  s_mov_b32 s11, 0x20000
  s_mov_b32 s48, s24
  s_mov_b32 s49, s25
  s_mov_b32 s51, 0x20000
  s_mul_i32 s46, s16, 20480
  v_lshrrev_b32 v2, 3, v0
  v_mul_lo_u32 v2, v2, s101
  v_and_b32 v3, 7, v0
  v_lshl_add_u32 v10, v3, 4, v2
  s_lshl_b32 s34, s101, 3
  s_sub_u32 s34, s34, 1024
  v_add_u32 v11, s34, v10
  v_add_u32 v12, s34, v11
  v_add_u32 v13, s34, v12
  v_lshrrev_b32 v2, 4, v0
  v_lshlrev_b32 v2, 10, v2
  v_bfe_u32 v3, v0, 2, 2
  v_lshl_add_u32 v2, v3, 7, v2
  v_and_b32_e64 v3, 3, v0
  v_lshl_add_u32 v2, v3, 3, v2
  v_add_u32 v14, s46, v2
  v_mov_b32 v32, 0
  v_mov_b32 v33, 0
  v_mov_b32 v34, 0
  v_mov_b32 v35, 0
  v_mov_b32 v36, 0
  v_mov_b32 v37, 0
  v_mov_b32 v38, 0
  v_mov_b32 v39, 0
  v_mov_b32 v40, 0
  v_mov_b32 v41, 0
  v_mov_b32 v42, 0
  v_mov_b32 v43, 0
  v_mov_b32 v44, 0
  v_mov_b32 v45, 0
  v_mov_b32 v46, 0
  v_mov_b32_e64 v47, 0
  v_mov_b32 v48, 0x3f803f80
  v_mov_b32 v49, 0x3f803f80
  v_mov_b32 v50, 0x3f803f80
  v_mov_b32 v51, 0x3f803f80
  s_waitcnt lgkmcnt(0)
  s_add_u32 s54, s54, 1
  s_barrier
  s_barrier
  s_and_b32 m0, s33, 0xfffff
  s_mov_b32 s89, 0x10000
  buffer_load_dwordx4 v1, s[12:15], s32 offen offset:0 sc1 lds
  buffer_load_dwordx4 v1, s[12:15], s32 offen offset:1024 sc1 lds
  buffer_load_dwordx4 v1, s[12:15], s32 offen offset:2048 sc1 lds
  buffer_load_dwordx4 v1, s[12:15], s32 offen offset:3072 sc1 lds
  s_add_u32 m0, s33, 4096
  s_add_u32 s34, s32, 4096
  buffer_load_dwordx4 v1, s[12:15], s34 offen sc1 lds
  s_add_u32 s32, s32, 10240
  s_waitcnt vmcnt(0)
  s_barrier
  s_add_u32 m0, s33, 20480
  s_mov_b32 s89, 0x10000
  buffer_load_dwordx4 v1, s[12:15], s32 offen offset:0 sc1 lds
  buffer_load_dwordx4 v1, s[12:15], s32 offen offset:1024 sc1 lds
  buffer_load_dwordx4 v1, s[12:15], s32 offen offset:2048 sc1 lds
  buffer_load_dwordx4 v1, s[12:15], s32 offen offset:3072 sc1 lds
  s_add_u32 m0, s33, 24576
  s_add_u32 s34, s32, 4096
  buffer_load_dwordx4 v1, s[12:15], s34 offen sc1 lds
  s_add_u32 s32, s32, 10240
  s_waitcnt vmcnt(0)
  s_barrier
  s_add_u32 m0, s33, 40960
  s_mov_b32 s89, 0x10000
  buffer_load_dwordx4 v1, s[12:15], s32 offen offset:0 sc1 lds
  buffer_load_dwordx4 v1, s[12:15], s32 offen offset:1024 sc1 lds
  buffer_load_dwordx4 v1, s[12:15], s32 offen offset:2048 sc1 lds
  buffer_load_dwordx4 v1, s[12:15], s32 offen offset:3072 sc1 lds
  s_add_u32 m0, s33, 45056
  s_add_u32 s34, s32, 4096
  buffer_load_dwordx4 v1, s[12:15], s34 offen sc1 lds
  s_add_u32 s32, s32, 10240
  s_and_b32 m0, s46, 0xfffff
  s_mov_b32 s89, 0x10000
  buffer_load_dwordx4 v10, s[8:11], s47 offen offset:0 lds
  buffer_load_dwordx4 v11, s[8:11], s47 offen offset:1024 lds
  buffer_load_dwordx4 v12, s[8:11], s47 offen offset:2048 lds
  buffer_load_dwordx4 v13, s[8:11], s47 offen offset:3072 lds
  s_add_u32 s47, s47, s52
  s_mov_b32 s10, s53
  s_add_u32 m0, s46, 4096
  s_mov_b32 s89, 0x10000
  buffer_load_dwordx4 v10, s[8:11], s47 offen offset:0 lds
  buffer_load_dwordx4 v11, s[8:11], s47 offen offset:1024 lds
  buffer_load_dwordx4 v12, s[8:11], s47 offen offset:2048 lds
  buffer_load_dwordx4 v13, s[8:11], s47 offen offset:3072 lds
  s_add_u32 s47, s47, s52
  s_mov_b32 s10, s53
  s_waitcnt vmcnt(8)
  s_barrier
  s_and_b32 m0, s33, 0xfffff
  s_mov_b32 s89, 0x10000
  buffer_load_dwordx4 v1, s[12:15], s32 offen offset:0 sc1 lds
  buffer_load_dwordx4 v1, s[12:15], s32 offen offset:1024 sc1 lds
  buffer_load_dwordx4 v1, s[12:15], s32 offen offset:2048 sc1 lds
  buffer_load_dwordx4 v1, s[12:15], s32 offen offset:3072 sc1 lds
  s_add_u32 m0, s33, 4096
  s_add_u32 s34, s32, 4096
  buffer_load_dwordx4 v1, s[12:15], s34 offen sc1 lds
  s_add_u32 s32, s32, 10240
  s_add_u32 m0, s46, 8192
  s_mov_b32 s89, 0x10000
  buffer_load_dwordx4 v10, s[8:11], s47 offen offset:0 lds
  buffer_load_dwordx4 v11, s[8:11], s47 offen offset:1024 lds
  buffer_load_dwordx4 v12, s[8:11], s47 offen offset:2048 lds
  buffer_load_dwordx4 v13, s[8:11], s47 offen offset:3072 lds
  s_add_u32 s47, s47, s52
  s_mov_b32 s10, s53
  s_add_u32 m0, s46, 12288
  s_mov_b32 s89, 0x10000
  buffer_load_dwordx4 v10, s[8:11], s47 offen offset:0 lds
  buffer_load_dwordx4 v11, s[8:11], s47 offen offset:1024 lds
  buffer_load_dwordx4 v12, s[8:11], s47 offen offset:2048 lds
  buffer_load_dwordx4 v13, s[8:11], s47 offen offset:3072 lds
  s_add_u32 s47, s47, s52
  s_mov_b32 s10, s53
  s_waitcnt vmcnt(8)
  s_barrier
  s_add_u32 m0, s33, 20480
  s_mov_b32 s89, 0x10000
  buffer_load_dwordx4 v1, s[12:15], s32 offen offset:0 sc1 lds
  buffer_load_dwordx4 v1, s[12:15], s32 offen offset:1024 sc1 lds
  buffer_load_dwordx4 v1, s[12:15], s32 offen offset:2048 sc1 lds
  buffer_load_dwordx4 v1, s[12:15], s32 offen offset:3072 sc1 lds
  s_add_u32 m0, s33, 24576
  s_add_u32 s34, s32, 4096
  buffer_load_dwordx4 v1, s[12:15], s34 offen sc1 lds
  s_add_u32 s32, s32, 10240
  s_waitcnt vmcnt(13)
  ds_read_b64_tr_b16 v[16:17], v14 offset:0
  ds_read_b64_tr_b16 v[18:19], v14 offset:512
  ds_read_b64_tr_b16 v[20:21], v14 offset:32
  ds_read_b64_tr_b16 v[22:23], v14 offset:544
  ds_read_b64_tr_b16 v[24:25], v14 offset:64
  ds_read_b64_tr_b16 v[26:27], v14 offset:576
  ds_read_b64_tr_b16 v[28:29], v14 offset:96
  ds_read_b64_tr_b16 v[30:31], v14 offset:608
  s_waitcnt lgkmcnt(6)
  buffer_store_dwordx4 v[16:19], v1, s[48:51], s96 offen sc1
  v_mfma_f32_16x16x32_bf16 v[32:35], v[48:51], v[16:19], v[32:35]
  s_add_u32 s96, s96, 221184
  s_waitcnt lgkmcnt(4)
  buffer_store_dwordx4 v[20:23], v1, s[48:51], s97 offen sc1
  v_mfma_f32_16x16x32_bf16 v[36:39], v[48:51], v[20:23], v[36:39]
  s_add_u32 s97, s97, 221184
  s_waitcnt lgkmcnt(2)
  buffer_store_dwordx4 v[24:27], v1, s[48:51], s98 offen sc1
  v_mfma_f32_16x16x32_bf16 v[40:43], v[48:51], v[24:27], v[40:43]
  s_add_u32 s98, s98, 221184
  s_waitcnt lgkmcnt(0)
  buffer_store_dwordx4 v[28:31], v1, s[48:51], s99 offen sc1
  v_mfma_f32_16x16x32_bf16 v[44:47], v[48:51], v[28:31], v[44:47]
  s_add_u32 s99, s99, 221184
  s_mov_b32 s50, s100
  s_nop 1
  s_waitcnt vmcnt(17)
  ds_read_b64_tr_b16 v[16:17], v14 offset:4096
  ds_read_b64_tr_b16 v[18:19], v14 offset:4608
  ds_read_b64_tr_b16 v[20:21], v14 offset:4128
  ds_read_b64_tr_b16 v[22:23], v14 offset:4640
  ds_read_b64_tr_b16 v[24:25], v14 offset:4160
  ds_read_b64_tr_b16 v[26:27], v14 offset:4672
  ds_read_b64_tr_b16 v[28:29], v14 offset:4192
  ds_read_b64_tr_b16 v[30:31], v14 offset:4704
  s_waitcnt lgkmcnt(6)
  buffer_store_dwordx4 v[16:19], v1, s[48:51], s96 offen sc1
  v_mfma_f32_16x16x32_bf16 v[32:35], v[48:51], v[16:19], v[32:35]
  s_add_u32 s96, s96, 221184
  s_waitcnt lgkmcnt(4)
  buffer_store_dwordx4 v[20:23], v1, s[48:51], s97 offen sc1
  v_mfma_f32_16x16x32_bf16 v[36:39], v[48:51], v[20:23], v[36:39]
  s_add_u32 s97, s97, 221184
  s_waitcnt lgkmcnt(2)
  buffer_store_dwordx4 v[24:27], v1, s[48:51], s98 offen sc1
  v_mfma_f32_16x16x32_bf16 v[40:43], v[48:51], v[24:27], v[40:43]
  s_add_u32 s98, s98, 221184
  s_waitcnt lgkmcnt(0)
  buffer_store_dwordx4 v[28:31], v1, s[48:51], s99 offen sc1
  v_mfma_f32_16x16x32_bf16 v[44:47], v[48:51], v[28:31], v[44:47]
  s_add_u32 s99, s99, 221184
  s_mov_b32 s50, s100
  s_nop 1
  s_add_u32 m0, s46, 16384
  s_mov_b32 s89, 0x10000
  buffer_load_dwordx4 v10, s[8:11], s47 offen offset:0 lds
  buffer_load_dwordx4 v11, s[8:11], s47 offen offset:1024 lds
  buffer_load_dwordx4 v12, s[8:11], s47 offen offset:2048 lds
  buffer_load_dwordx4 v13, s[8:11], s47 offen offset:3072 lds
  s_add_u32 s47, s47, s52
  s_mov_b32 s10, s53
  s_waitcnt vmcnt(12)
  s_barrier
  s_cmp_eq_u32 s95, 2146435072
  s_cbranch_scc1 RT_F
  s_waitcnt vmcnt(0)
  v_mov_b32 v2, s54
  v_mov_b32_e64 v3, s95
  s_mov_b64 exec, 1
  buffer_store_dword v2, v3, s[12:15], 0 offen sc1
  s_mov_b64 exec, -1
RT_F:
  s_add_u32 m0, s33, 40960
  s_mov_b32 s89, 0x10000
  buffer_load_dwordx4 v1, s[12:15], s32 offen offset:0 sc1 lds
  buffer_load_dwordx4 v1, s[12:15], s32 offen offset:1024 sc1 lds
  buffer_load_dwordx4 v1, s[12:15], s32 offen offset:2048 sc1 lds
  buffer_load_dwordx4 v1, s[12:15], s32 offen offset:3072 sc1 lds
  s_add_u32 m0, s33, 45056
  s_add_u32 s34, s32, 4096
  buffer_load_dwordx4 v1, s[12:15], s34 offen sc1 lds
  s_add_u32 s32, s32, 10240
  s_waitcnt vmcnt(17)
  ds_read_b64_tr_b16 v[16:17], v14 offset:8192
  ds_read_b64_tr_b16 v[18:19], v14 offset:8704
  ds_read_b64_tr_b16 v[20:21], v14 offset:8224
  ds_read_b64_tr_b16 v[22:23], v14 offset:8736
  ds_read_b64_tr_b16 v[24:25], v14 offset:8256
  ds_read_b64_tr_b16 v[26:27], v14 offset:8768
  ds_read_b64_tr_b16 v[28:29], v14 offset:8288
  ds_read_b64_tr_b16 v[30:31], v14 offset:8800
  s_waitcnt lgkmcnt(6)
  buffer_store_dwordx4 v[16:19], v1, s[48:51], s96 offen sc1
  v_mfma_f32_16x16x32_bf16 v[32:35], v[48:51], v[16:19], v[32:35]
  s_add_u32 s96, s96, 221184
  s_waitcnt lgkmcnt(4)
  buffer_store_dwordx4 v[20:23], v1, s[48:51], s97 offen sc1
  v_mfma_f32_16x16x32_bf16 v[36:39], v[48:51], v[20:23], v[36:39]
  s_add_u32 s97, s97, 221184
  s_waitcnt lgkmcnt(2)
  buffer_store_dwordx4 v[24:27], v1, s[48:51], s98 offen sc1
  v_mfma_f32_16x16x32_bf16 v[40:43], v[48:51], v[24:27], v[40:43]
  s_add_u32 s98, s98, 221184
  s_waitcnt lgkmcnt(0)
  buffer_store_dwordx4 v[28:31], v1, s[48:51], s99 offen sc1
  v_mfma_f32_16x16x32_bf16 v[44:47], v[48:51], v[28:31], v[44:47]
  s_add_u32 s99, s99, 221184
  s_mov_b32 s50, s100
  s_nop 1
  s_waitcnt vmcnt(21)
  ds_read_b64_tr_b16 v[16:17], v14 offset:12288
  ds_read_b64_tr_b16 v[18:19], v14 offset:12800
  ds_read_b64_tr_b16 v[20:21], v14 offset:12320
  ds_read_b64_tr_b16 v[22:23], v14 offset:12832
  ds_read_b64_tr_b16 v[24:25], v14 offset:12352
  ds_read_b64_tr_b16 v[26:27], v14 offset:12864
  ds_read_b64_tr_b16 v[28:29], v14 offset:12384
  ds_read_b64_tr_b16 v[30:31], v14 offset:12896
  s_waitcnt lgkmcnt(6)
  buffer_store_dwordx4 v[16:19], v1, s[48:51], s96 offen sc1
  v_mfma_f32_16x16x32_bf16 v[32:35], v[48:51], v[16:19], v[32:35]
  s_add_u32 s96, s96, 221184
  s_waitcnt lgkmcnt(4)
  buffer_store_dwordx4 v[20:23], v1, s[48:51], s97 offen sc1
  v_mfma_f32_16x16x32_bf16 v[36:39], v[48:51], v[20:23], v[36:39]
  s_add_u32 s97, s97, 221184
  s_waitcnt lgkmcnt(2)
  buffer_store_dwordx4 v[24:27], v1, s[48:51], s98 offen sc1
  v_mfma_f32_16x16x32_bf16 v[40:43], v[48:51], v[24:27], v[40:43]
  s_add_u32 s98, s98, 221184
  s_waitcnt lgkmcnt(0)
  buffer_store_dwordx4 v[28:31], v1, s[48:51], s99 offen sc1
  v_mfma_f32_16x16x32_bf16 v[44:47], v[48:51], v[28:31], v[44:47]
  s_add_u32 s99, s99, 221184
  s_mov_b32 s50, s100
  s_nop 1
  s_lshr_b32 s34, s17, 1
  s_mul_i32 s34, s34, 2560
  s_lshl_b32 s37, s18, 3
  s_lshl_b32 s38, s16, 1
  s_add_u32 s37, s37, s38
  s_mul_i32 s37, s37, 40960
  s_add_u32 s34, s34, s37
  s_add_u32 s34, s34, 9438208
  v_lshrrev_b32 v2, 2, v0
  v_mul_u32_u24 v2, 40960, v2
  v_and_b32 v3, 3, v0
  v_lshl_add_u32 v2, v3, 7, v2
  s_mov_b64 exec, 0xff
  buffer_load_dword v8, v2, s[12:15], s34 offen sc1
  s_mov_b64 exec, -1
  s_waitcnt vmcnt(9)
  s_barrier
  s_and_b32 m0, s33, 0xfffff
  s_mov_b32 s89, 0x10000
  buffer_load_dwordx4 v1, s[12:15], s32 offen offset:0 sc1 lds
  buffer_load_dwordx4 v1, s[12:15], s32 offen offset:1024 sc1 lds
  buffer_load_dwordx4 v1, s[12:15], s32 offen offset:2048 sc1 lds
  buffer_load_dwordx4 v1, s[12:15], s32 offen offset:3072 sc1 lds
  s_add_u32 m0, s33, 4096
  s_add_u32 s34, s32, 4096
  buffer_load_dwordx4 v1, s[12:15], s34 offen sc1 lds
  s_add_u32 s32, s32, 10240
  s_waitcnt vmcnt(14)
  ds_read_b64_tr_b16 v[16:17], v14 offset:16384
  ds_read_b64_tr_b16 v[18:19], v14 offset:16896
  ds_read_b64_tr_b16 v[20:21], v14 offset:16416
  ds_read_b64_tr_b16 v[22:23], v14 offset:16928
  ds_read_b64_tr_b16 v[24:25], v14 offset:16448
  ds_read_b64_tr_b16 v[26:27], v14 offset:16960
  ds_read_b64_tr_b16 v[28:29], v14 offset:16480
  ds_read_b64_tr_b16 v[30:31], v14 offset:16992
  s_waitcnt lgkmcnt(6)
  buffer_store_dwordx4 v[16:19], v1, s[48:51], s96 offen sc1
  v_mfma_f32_16x16x32_bf16 v[32:35], v[48:51], v[16:19], v[32:35]
  s_add_u32 s96, s96, 221184
  s_waitcnt lgkmcnt(4)
  buffer_store_dwordx4 v[20:23], v1, s[48:51], s97 offen sc1
  v_mfma_f32_16x16x32_bf16 v[36:39], v[48:51], v[20:23], v[36:39]
  s_add_u32 s97, s97, 221184
  s_waitcnt lgkmcnt(2)
  buffer_store_dwordx4 v[24:27], v1, s[48:51], s98 offen sc1
  v_mfma_f32_16x16x32_bf16 v[40:43], v[48:51], v[24:27], v[40:43]
  s_add_u32 s98, s98, 221184
  s_waitcnt lgkmcnt(0)
  buffer_store_dwordx4 v[28:31], v1, s[48:51], s99 offen sc1
  v_mfma_f32_16x16x32_bf16 v[44:47], v[48:51], v[28:31], v[44:47]
  s_add_u32 s99, s99, 221184
  s_mov_b32 s50, s100
  s_nop 1
  s_nop 7
  s_lshl_b32 s34, s16, 8
  s_add_u32 s34, s34, 98304
  v_lshl_add_u32 v2, v0, 2, s34
  s_mov_b64 exec, 0xffff
  ds_write_b32 v2, v32 offset:0
  ds_write_b32 v2, v36 offset:64
  ds_write_b32 v2, v40 offset:128
  ds_write_b32 v2, v44 offset:192
  s_mov_b64 exec, -1
  s_waitcnt lgkmcnt(0)
  s_waitcnt vmcnt(4)
  s_barrier
  s_mov_b32 s37, 23867392
  s_mov_b32 exec_lo, 0xffffffff
  s_mov_b32 exec_hi, 0x3ffff
  s_mov_b32 s39, 0
POLL_11_P:
  s_add_u32 s39, s39, 1
  s_cmp_gt_u32 s39, 400000
  s_cbranch_scc1 POLL_11_X
  buffer_load_dwordx4 v[20:23], v1, s[12:15], s37 offen sc1
  s_waitcnt vmcnt(0)
  v_xor_b32 v20, s54, v20
  v_xor_b32 v21, s54, v21
  v_xor_b32 v22, s54, v22
  v_xor_b32 v23, s54, v23
  v_or3_b32 v20, v20, v21, v22
  v_or_b32 v20, v20, v23
  v_cmp_ne_u32 vcc, 0, v20
  s_nop 4
  s_cbranch_vccnz POLL_11_P
POLL_11_X:
  s_mov_b64 exec, -1
POLL_11_Q:
  s_add_u32 m0, s33, 20480
  s_mov_b32 s89, 0x10000
  buffer_load_dwordx4 v1, s[12:15], s32 offen offset:0 sc1 lds
  buffer_load_dwordx4 v1, s[12:15], s32 offen offset:1024 sc1 lds
  buffer_load_dwordx4 v1, s[12:15], s32 offen offset:2048 sc1 lds
  buffer_load_dwordx4 v1, s[12:15], s32 offen offset:3072 sc1 lds
  s_add_u32 m0, s33, 24576
  s_add_u32 s34, s32, 4096
  buffer_load_dwordx4 v1, s[12:15], s34 offen sc1 lds
  s_add_u32 s32, s32, 10240
  v_lshlrev_b32_e64 v2, 2, v0
  v_add_u32 v3, 98304, v2
  ds_read_b32 v16, v3 offset:0
  ds_read_b32 v17, v3 offset:256
  ds_read_b32 v18, v3 offset:512
  ds_read_b32 v19, v3 offset:768
  s_lshl_b32 s34, s2, 8
  s_add_u32 s34, s34, 23592960
  s_cmp_eq_u32 s16, 0
  s_cselect_b32 s50, s100, 0
  s_waitcnt lgkmcnt(0)
  v_add_f32 v16, v16, v17
  v_add_f32 v18, v18, v19
  v_add_f32_e64 v16, v16, v18
  buffer_store_dword v16, v2, s[48:51], s34 offen sc1
  s_and_b32 m0, s35, 0xfffff
  s_cmp_ge_u32 s35, 6144
  buffer_load_dwordx4 v1, s[12:15], s36 offen offset:0 sc1 lds
  buffer_load_dwordx4 v1, s[12:15], s36 offen offset:1024 sc1 lds
  s_cbranch_scc1 FR_12
  s_nop 0
  buffer_load_dwordx4 v1, s[12:15], s36 offen offset:2048 sc1 lds
FR_12:
  s_add_u32 s36, s36, 10240
  s_add_u32 m0, s35, 10240
  s_cmp_ge_u32 s35, 6144
  buffer_load_dwordx4 v1, s[12:15], s36 offen offset:0 sc1 lds
  buffer_load_dwordx4 v1, s[12:15], s36 offen offset:1024 sc1 lds
  s_cbranch_scc1 FR_13
  s_nop 0
  buffer_load_dwordx4 v1, s[12:15], s36 offen offset:2048 sc1 lds
FR_13:
  s_add_u32 s36, s36, 10240
  s_add_u32 m0, s35, 20480
  s_cmp_ge_u32 s35, 6144
  buffer_load_dwordx4 v1, s[12:15], s36 offen offset:0 sc1 lds
  buffer_load_dwordx4 v1, s[12:15], s36 offen offset:1024 sc1 lds
  s_cbranch_scc1 FR_14
  s_nop 0
  buffer_load_dwordx4 v1, s[12:15], s36 offen offset:2048 sc1 lds
FR_14:
  s_add_u32 s36, s36, 10240
  s_add_u32 m0, s35, 30720
  s_cmp_ge_u32 s35, 6144
  buffer_load_dwordx4 v1, s[12:15], s36 offen offset:0 sc1 lds
  buffer_load_dwordx4 v1, s[12:15], s36 offen offset:1024 sc1 lds
  s_cbranch_scc1 FR_15
  s_nop 0
  buffer_load_dwordx4 v1, s[12:15], s36 offen offset:2048 sc1 lds
FR_15:
  s_add_u32 s36, s36, 10240
  s_waitcnt vmcnt(9)
  s_barrier
  s_add_u32 m0, s35, 40960
  s_cmp_ge_u32 s35, 6144
  buffer_load_dwordx4 v1, s[12:15], s36 offen offset:0 sc1 lds
  buffer_load_dwordx4 v1, s[12:15], s36 offen offset:1024 sc1 lds
  s_cbranch_scc1 FR_16
  s_nop 0
  buffer_load_dwordx4 v1, s[12:15], s36 offen offset:2048 sc1 lds
FR_16:
  s_add_u32 s36, s36, 10240
  s_add_u32 m0, s35, 51200
  s_cmp_ge_u32 s35, 6144
  buffer_load_dwordx4 v1, s[12:15], s36 offen offset:0 sc1 lds
  buffer_load_dwordx4 v1, s[12:15], s36 offen offset:1024 sc1 lds
  s_cbranch_scc1 FR_17
  s_nop 0
  buffer_load_dwordx4 v1, s[12:15], s36 offen offset:2048 sc1 lds
FR_17:
  s_add_u32 s36, s36, 10240
  s_add_u32 m0, s35, 61440
  s_cmp_ge_u32 s35, 6144
  buffer_load_dwordx4 v1, s[12:15], s36 offen offset:0 sc1 lds
  buffer_load_dwordx4 v1, s[12:15], s36 offen offset:1024 sc1 lds
  s_cbranch_scc1 FR_18
  s_nop 0
  buffer_load_dwordx4 v1, s[12:15], s36 offen offset:2048 sc1 lds
FR_18:
  s_add_u32 s36, s36, 10240
  s_add_u32 m0, s35, 71680
  s_cmp_ge_u32 s35, 6144
  buffer_load_dwordx4 v1, s[12:15], s36 offen offset:0 sc1 lds
  buffer_load_dwordx4 v1, s[12:15], s36 offen offset:1024 sc1 lds
  s_cbranch_scc1 FR_19
  s_nop 0
  buffer_load_dwordx4 v1, s[12:15], s36 offen offset:2048 sc1 lds
FR_19:
  s_add_u32 s36, s36, 10240
  s_barrier
  s_setprio 0
  s_barrier
  s_waitcnt vmcnt(0)
  s_lshl_b32 s32, s40, 1
  s_lshr_b32 s33, s16, 1
  s_add_u32 s32, s32, s33
  s_mul_i32 s32, s32, 40960
  s_and_b32 s33, s16, 1
  s_lshl_b32 s33, s33, 11
  s_add_u32 s32, s32, s33
  s_add_u32 s32, s32, 9437184
  s_lshl_b32 s33, s16, 11
  s_add_u32 s33, s33, 98304
  s_barrier
  s_barrier
  s_and_b32 m0, s33, 0xfffff
  s_mov_b32 s89, 0x10000
  buffer_load_dwordx4 v1, s[12:15], s32 offen sc1 lds
  buffer_load_dwordx4 v1, s[12:15], s32 offen offset:1024 sc1 lds
  s_add_u32 s32, s32, 4096
  s_add_u32 m0, s33, 8192
  s_mov_b32 s89, 0x10000
  buffer_load_dwordx4 v1, s[12:15], s32 offen sc1 lds
  buffer_load_dwordx4 v1, s[12:15], s32 offen offset:1024 sc1 lds
  s_add_u32 s32, s32, 4096
  s_add_u32 m0, s33, 16384
  s_mov_b32 s89, 0x10000
  buffer_load_dwordx4 v1, s[12:15], s32 offen sc1 lds
  buffer_load_dwordx4 v1, s[12:15], s32 offen offset:1024 sc1 lds
  s_add_u32 s32, s32, 4096
  s_add_u32 m0, s33, 24576
  s_mov_b32 s89, 0x10000
  buffer_load_dwordx4 v1, s[12:15], s32 offen sc1 lds
  buffer_load_dwordx4 v1, s[12:15], s32 offen offset:1024 sc1 lds
  s_add_u32 s32, s32, 4096
  s_add_u32 m0, s33, 32768
  s_mov_b32 s89, 0x10000
  buffer_load_dwordx4 v1, s[12:15], s32 offen sc1 lds
  buffer_load_dwordx4 v1, s[12:15], s32 offen offset:1024 sc1 lds
  s_add_u32 s32, s32, 4096
  s_add_u32 m0, s33, 40960
  s_mov_b32 s89, 0x10000
  buffer_load_dwordx4 v1, s[12:15], s32 offen sc1 lds
  buffer_load_dwordx4 v1, s[12:15], s32 offen offset:1024 sc1 lds
  s_add_u32 s32, s32, 4096
  s_add_u32 m0, s33, 49152
  s_mov_b32 s89, 0x10000
  buffer_load_dwordx4 v1, s[12:15], s32 offen sc1 lds
  buffer_load_dwordx4 v1, s[12:15], s32 offen offset:1024 sc1 lds
  s_add_u32 s32, s32, 4096
  s_add_u32 m0, s33, 57344
  s_mov_b32 s89, 0x10000
  buffer_load_dwordx4 v1, s[12:15], s32 offen sc1 lds
  buffer_load_dwordx4 v1, s[12:15], s32 offen offset:1024 sc1 lds
  s_add_u32 s32, s32, 4096
  s_waitcnt vmcnt(14)
  s_barrier
  s_waitcnt vmcnt(12)
  s_barrier
  s_waitcnt vmcnt(10)
  s_barrier
  s_and_b32 m0, s33, 0xfffff
  s_mov_b32 s89, 0x10000
  buffer_load_dwordx4 v1, s[12:15], s32 offen sc1 lds
  buffer_load_dwordx4 v1, s[12:15], s32 offen offset:1024 sc1 lds
  s_add_u32 s32, s32, 4096
  s_and_b32 m0, s35, 0xfffff
  s_cmp_ge_u32 s35, 6144
  buffer_load_dwordx4 v1, s[12:15], s36 offen offset:0 sc1 lds
  buffer_load_dwordx4 v1, s[12:15], s36 offen offset:1024 sc1 lds
  s_cbranch_scc1 FR_20
  s_nop 0
  buffer_load_dwordx4 v1, s[12:15], s36 offen offset:2048 sc1 lds
FR_20:
  s_add_u32 s36, s36, 10240
  s_waitcnt vmcnt(12)
  s_barrier
  s_add_u32 m0, s33, 8192
  s_mov_b32 s89, 0x10000
  buffer_load_dwordx4 v1, s[12:15], s32 offen sc1 lds
  buffer_load_dwordx4 v1, s[12:15], s32 offen offset:1024 sc1 lds
  s_add_u32 s32, s32, 4096
  s_add_u32 m0, s35, 10240
  s_cmp_ge_u32 s35, 6144
  buffer_load_dwordx4 v1, s[12:15], s36 offen offset:0 sc1 lds
  buffer_load_dwordx4 v1, s[12:15], s36 offen offset:1024 sc1 lds
  s_cbranch_scc1 FR_21
  s_nop 0
  buffer_load_dwordx4 v1, s[12:15], s36 offen offset:2048 sc1 lds
FR_21:
  s_add_u32 s36, s36, 10240
  s_waitcnt vmcnt(14)
  s_barrier
  s_waitcnt vmcnt(12)
  s_barrier
  s_waitcnt vmcnt(10)
  s_barrier
  s_mov_b32 s37, 23859200
  buffer_load_dwordx4 v[16:19], v1, s[12:15], s37 offen sc1
  s_waitcnt vmcnt(8)
  s_barrier
  s_waitcnt vmcnt(4)
  s_barrier
  s_waitcnt vmcnt(0)
  s_barrier
  s_cmp_lg_u32 s16, 0
  s_cbranch_scc1 POLL_22_Q
  s_mov_b32 s39, 0
  s_branch POLL_22_C
POLL_22_P:
  s_add_u32 s39, s39, 1
  s_cmp_gt_u32 s39, 400000
  s_cbranch_scc1 POLL_22_X
  buffer_load_dwordx4 v[16:19], v1, s[12:15], s37 offen sc1
POLL_22_C:
  s_waitcnt vmcnt(0)
  v_xor_b32 v16, s54, v16
  v_xor_b32 v17, s54, v17
  v_xor_b32 v18, s54, v18
  v_xor_b32 v19, s54, v19
  v_or3_b32 v16, v16, v17, v18
  v_or_b32 v16, v16, v19
  v_cmp_ne_u32 vcc, 0, v16
  s_nop 4
  s_cbranch_vccnz POLL_22_P
POLL_22_X:
  s_mov_b64 exec, -1
  s_cmp_lg_u32 s2, 0
  s_cbranch_scc1 POLL_22_Q
  v_mov_b32 v2, s54
  v_mov_b32 v3, 23863296
  s_mov_b64 exec, 1
  buffer_store_dword v2, v3, s[12:15], 0 offen sc1
  s_mov_b64 exec, -1
POLL_22_Q:
  s_barrier
  s_lshl_b32 s35, s16, 11
  s_lshl_b32 s36, s3, 13
  s_add_u32 s36, s36, s35
  s_add_u32 s36, s36, 25165824
  s_lshl_b32 s32, s43, 2
  s_add_u32 s32, s32, s16
  s_mul_i32 s32, s32, 40960
  s_add_u32 s32, s32, 12582912
  s_lshl_b32 s33, s16, 11
  s_lshl_b32 s34, s16, 10
  s_add_u32 m0, s34, 81920
  s_lshl_b32 s34, s3, 2
  s_cmp_ge_u32 s16, 2
  s_cselect_b32 s34, s44, s34
  s_lshl_b32 s34, s34, 6
  s_and_b32 s37, s16, 1
  s_mul_i32 s37, s37, 6912
  s_add_u32 s34, s34, s37
  s_add_u32 s34, s34, 23592960
  buffer_load_dwordx4 v1, s[12:15], s34 offen sc1 lds
  v_and_b32 v8, 15, v0
  v_lshlrev_b32_e64 v8, 7, v8
  s_barrier
  s_add_u32 m0, s35, 8192
  s_mov_b32 s89, 0x10000
  buffer_load_dwordx4 v1, s[12:15], s36 offen sc1 lds
  buffer_load_dwordx4 v1, s[12:15], s36 offen offset:1024 sc1 lds
  s_add_u32 s36, s36, 221184
  s_add_u32 m0, s35, 24576
  s_mov_b32 s89, 0x10000
  buffer_load_dwordx4 v1, s[12:15], s36 offen sc1 lds
  buffer_load_dwordx4 v1, s[12:15], s36 offen offset:1024 sc1 lds
  s_add_u32 s36, s36, 221184
  s_add_u32 m0, s35, 40960
  s_mov_b32 s89, 0x10000
  buffer_load_dwordx4 v1, s[12:15], s36 offen sc1 lds
  buffer_load_dwordx4 v1, s[12:15], s36 offen offset:1024 sc1 lds
  s_add_u32 s36, s36, 221184
  s_add_u32 m0, s35, 57344
  s_mov_b32 s89, 0x10000
  buffer_load_dwordx4 v1, s[12:15], s36 offen sc1 lds
  buffer_load_dwordx4 v1, s[12:15], s36 offen offset:1024 sc1 lds
  s_add_u32 s36, s36, 221184
  s_add_u32 m0, s35, 106496
  s_mov_b32 s89, 0x10000
  buffer_load_dwordx4 v1, s[12:15], s36 offen sc1 lds
  buffer_load_dwordx4 v1, s[12:15], s36 offen offset:1024 sc1 lds
  s_add_u32 s36, s36, 221184
  s_add_u32 m0, s35, 122880
  s_mov_b32 s89, 0x10000
  buffer_load_dwordx4 v1, s[12:15], s36 offen sc1 lds
  buffer_load_dwordx4 v1, s[12:15], s36 offen offset:1024 sc1 lds
  s_add_u32 s36, s36, 221184
  s_add_u32 m0, s35, 139264
  s_mov_b32 s89, 0x10000
  buffer_load_dwordx4 v1, s[12:15], s36 offen sc1 lds
  buffer_load_dwordx4 v1, s[12:15], s36 offen offset:1024 sc1 lds
  s_add_u32 s36, s36, 221184
  s_add_u32 m0, s35, 155648
  s_mov_b32 s89, 0x10000
  buffer_load_dwordx4 v1, s[12:15], s36 offen sc1 lds
  buffer_load_dwordx4 v1, s[12:15], s36 offen offset:1024 sc1 lds
  s_add_u32 s36, s36, 221184
  s_barrier
  s_and_b32 m0, s33, 0xfffff
  s_mov_b32 s89, 0x10000
  buffer_load_dwordx4 v1, s[12:15], s32 offen sc1 lds
  buffer_load_dwordx4 v1, s[12:15], s32 offen offset:1024 sc1 lds
  s_add_u32 s32, s32, 2048
  s_add_u32 m0, s33, 16384
  s_mov_b32 s89, 0x10000
  buffer_load_dwordx4 v1, s[12:15], s32 offen sc1 lds
  buffer_load_dwordx4 v1, s[12:15], s32 offen offset:1024 sc1 lds
  s_add_u32 s32, s32, 2048
  s_add_u32 m0, s33, 32768
  s_mov_b32 s89, 0x10000
  buffer_load_dwordx4 v1, s[12:15], s32 offen sc1 lds
  buffer_load_dwordx4 v1, s[12:15], s32 offen offset:1024 sc1 lds
  s_add_u32 s32, s32, 2048
  s_add_u32 m0, s33, 49152
  s_mov_b32 s89, 0x10000
  buffer_load_dwordx4 v1, s[12:15], s32 offen sc1 lds
  buffer_load_dwordx4 v1, s[12:15], s32 offen offset:1024 sc1 lds
  s_add_u32 s32, s32, 2048
  s_waitcnt vmcnt(4)
  s_barrier
  s_add_u32 m0, s33, 98304
  s_mov_b32 s89, 0x10000
  buffer_load_dwordx4 v1, s[12:15], s32 offen sc1 lds
  buffer_load_dwordx4 v1, s[12:15], s32 offen offset:1024 sc1 lds
  s_add_u32 s32, s32, 2048
  s_add_u32 m0, s33, 114688
  s_mov_b32 s89, 0x10000
  buffer_load_dwordx4 v1, s[12:15], s32 offen sc1 lds
  buffer_load_dwordx4 v1, s[12:15], s32 offen offset:1024 sc1 lds
  s_add_u32 s32, s32, 2048
  s_add_u32 m0, s33, 131072
  s_mov_b32 s89, 0x10000
  buffer_load_dwordx4 v1, s[12:15], s32 offen sc1 lds
  buffer_load_dwordx4 v1, s[12:15], s32 offen offset:1024 sc1 lds
  s_add_u32 s32, s32, 2048
  s_add_u32 m0, s33, 147456
  s_mov_b32 s89, 0x10000
  buffer_load_dwordx4 v1, s[12:15], s32 offen sc1 lds
  buffer_load_dwordx4 v1, s[12:15], s32 offen offset:1024 sc1 lds
  s_add_u32 s32, s32, 2048
  s_waitcnt vmcnt(8)
  s_barrier
  s_and_b32 m0, s33, 0xfffff
  s_mov_b32 s89, 0x10000
  buffer_load_dwordx4 v1, s[12:15], s32 offen sc1 lds
  buffer_load_dwordx4 v1, s[12:15], s32 offen offset:1024 sc1 lds
  s_add_u32 s32, s32, 2048
  s_add_u32 m0, s33, 16384
  s_mov_b32 s89, 0x10000
  buffer_load_dwordx4 v1, s[12:15], s32 offen sc1 lds
  buffer_load_dwordx4 v1, s[12:15], s32 offen offset:1024 sc1 lds
  s_add_u32 s32, s32, 2048
  s_add_u32 m0, s35, 8192
  s_mov_b32 s89, 0x10000
  buffer_load_dwordx4 v1, s[12:15], s36 offen sc1 lds
  buffer_load_dwordx4 v1, s[12:15], s36 offen offset:1024 sc1 lds
  s_add_u32 s36, s36, 221184
  s_add_u32 m0, s35, 24576
  s_mov_b32 s89, 0x10000
  buffer_load_dwordx4 v1, s[12:15], s36 offen sc1 lds
  buffer_load_dwordx4 v1, s[12:15], s36 offen offset:1024 sc1 lds
  s_add_u32 s36, s36, 221184
  s_waitcnt vmcnt(12)
  s_barrier
  s_add_u32 m0, s33, 32768
  s_mov_b32 s89, 0x10000
  buffer_load_dwordx4 v1, s[12:15], s32 offen sc1 lds
  buffer_load_dwordx4 v1, s[12:15], s32 offen offset:1024 sc1 lds
  s_add_u32 s32, s32, 2048
  s_add_u32 m0, s33, 49152
  s_mov_b32 s89, 0x10000
  buffer_load_dwordx4 v1, s[12:15], s32 offen sc1 lds
  buffer_load_dwordx4 v1, s[12:15], s32 offen offset:1024 sc1 lds
  s_add_u32 s32, s32, 2048
  s_add_u32 m0, s35, 40960
  s_mov_b32 s89, 0x10000
  buffer_load_dwordx4 v1, s[12:15], s36 offen sc1 lds
  buffer_load_dwordx4 v1, s[12:15], s36 offen offset:1024 sc1 lds
  s_add_u32 s36, s36, 221184
  s_add_u32 m0, s35, 57344
  s_mov_b32 s89, 0x10000
  buffer_load_dwordx4 v1, s[12:15], s36 offen sc1 lds
  buffer_load_dwordx4 v1, s[12:15], s36 offen offset:1024 sc1 lds
  s_add_u32 s36, s36, 221184
  s_waitcnt vmcnt(16)
  s_barrier
  s_add_u32 m0, s33, 98304
  s_mov_b32 s89, 0x10000
  buffer_load_dwordx4 v1, s[12:15], s32 offen sc1 lds
  buffer_load_dwordx4 v1, s[12:15], s32 offen offset:1024 sc1 lds
  s_add_u32 s32, s32, 2048
  s_add_u32 m0, s33, 114688
  s_mov_b32 s89, 0x10000
  buffer_load_dwordx4 v1, s[12:15], s32 offen sc1 lds
  buffer_load_dwordx4 v1, s[12:15], s32 offen offset:1024 sc1 lds
  s_add_u32 s32, s32, 2048
  s_add_u32 m0, s35, 106496
  s_mov_b32 s89, 0x10000
  buffer_load_dwordx4 v1, s[12:15], s36 offen sc1 lds
  buffer_load_dwordx4 v1, s[12:15], s36 offen offset:1024 sc1 lds
  s_add_u32 s36, s36, 221184
  s_add_u32 m0, s35, 122880
  s_mov_b32 s89, 0x10000
  buffer_load_dwordx4 v1, s[12:15], s36 offen sc1 lds
  buffer_load_dwordx4 v1, s[12:15], s36 offen offset:1024 sc1 lds
  s_add_u32 s36, s36, 221184
  s_waitcnt vmcnt(16)
  s_barrier
  s_add_u32 m0, s33, 131072
  s_mov_b32 s89, 0x10000
  buffer_load_dwordx4 v1, s[12:15], s32 offen sc1 lds
  buffer_load_dwordx4 v1, s[12:15], s32 offen offset:1024 sc1 lds
  s_add_u32 s32, s32, 2048
  s_add_u32 m0, s33, 147456
  s_mov_b32 s89, 0x10000
  buffer_load_dwordx4 v1, s[12:15], s32 offen sc1 lds
  buffer_load_dwordx4 v1, s[12:15], s32 offen offset:1024 sc1 lds
  s_add_u32 s32, s32, 2048
  s_add_u32 m0, s35, 139264
  s_mov_b32 s89, 0x10000
  buffer_load_dwordx4 v1, s[12:15], s36 offen sc1 lds
  buffer_load_dwordx4 v1, s[12:15], s36 offen offset:1024 sc1 lds
  s_add_u32 s36, s36, 221184
  s_add_u32 m0, s35, 155648
  s_mov_b32 s89, 0x10000
  buffer_load_dwordx4 v1, s[12:15], s36 offen sc1 lds
  buffer_load_dwordx4 v1, s[12:15], s36 offen offset:1024 sc1 lds
  s_add_u32 s36, s36, 221184
  s_waitcnt vmcnt(16)
  s_barrier
  s_and_b32 m0, s33, 0xfffff
  s_mov_b32 s89, 0x10000
  buffer_load_dwordx4 v1, s[12:15], s32 offen sc1 lds
  buffer_load_dwordx4 v1, s[12:15], s32 offen offset:1024 sc1 lds
  s_add_u32 s32, s32, 2048
  s_add_u32 m0, s33, 16384
  s_mov_b32 s89, 0x10000
  buffer_load_dwordx4 v1, s[12:15], s32 offen sc1 lds
  buffer_load_dwordx4 v1, s[12:15], s32 offen offset:1024 sc1 lds
  s_add_u32 s32, s32, 2048
  s_add_u32 m0, s35, 8192
  s_mov_b32 s89, 0x10000
  buffer_load_dwordx4 v1, s[12:15], s36 offen sc1 lds
  buffer_load_dwordx4 v1, s[12:15], s36 offen offset:1024 sc1 lds
  s_add_u32 s36, s36, 221184
  s_add_u32 m0, s35, 24576
  s_mov_b32 s89, 0x10000
  buffer_load_dwordx4 v1, s[12:15], s36 offen sc1 lds
  buffer_load_dwordx4 v1, s[12:15], s36 offen offset:1024 sc1 lds
  s_add_u32 s36, s36, 221184
  s_waitcnt vmcnt(16)
  s_barrier
  s_add_u32 m0, s33, 32768
  s_mov_b32 s89, 0x10000
  buffer_load_dwordx4 v1, s[12:15], s32 offen sc1 lds
  buffer_load_dwordx4 v1, s[12:15], s32 offen offset:1024 sc1 lds
  s_add_u32 s32, s32, 2048
  s_add_u32 m0, s33, 49152
  s_mov_b32 s89, 0x10000
  buffer_load_dwordx4 v1, s[12:15], s32 offen sc1 lds
  buffer_load_dwordx4 v1, s[12:15], s32 offen offset:1024 sc1 lds
  s_add_u32 s32, s32, -38912
  s_add_u32 m0, s35, 40960
  s_mov_b32 s89, 0x10000
  buffer_load_dwordx4 v1, s[12:15], s36 offen sc1 lds
  buffer_load_dwordx4 v1, s[12:15], s36 offen offset:1024 sc1 lds
  s_add_u32 s36, s36, 221184
  s_add_u32 m0, s35, 57344
  s_mov_b32 s89, 0x10000
  buffer_load_dwordx4 v1, s[12:15], s36 offen sc1 lds
  buffer_load_dwordx4 v1, s[12:15], s36 offen offset:1024 sc1 lds
  s_add_u32 s36, s36, 221184
  s_waitcnt vmcnt(16)
  s_barrier
  s_mul_i32 s35, s16, 1
  s_min_u32 s34, s16, 2
  s_add_u32 s35, s35, s34
  s_lshl_b32 s35, s35, 10
  s_lshl_b32 s36, s44, 11
  s_add_u32 s36, s36, s35
  s_add_u32 s36, s36, 27820032
  s_add_u32 m0, s35, 106496
  s_cmp_ge_u32 s35, 4096
  buffer_load_dwordx4 v1, s[12:15], s36 offen offset:0 sc1 lds
  s_cbranch_scc1 FR_23
  s_nop 0
  buffer_load_dwordx4 v1, s[12:15], s36 offen offset:1024 sc1 lds
FR_23:
  s_add_u32 s36, s36, 221184
  s_add_u32 m0, s35, 122880
  s_cmp_ge_u32 s35, 4096
  buffer_load_dwordx4 v1, s[12:15], s36 offen offset:0 sc1 lds
  s_cbranch_scc1 FR_24
  s_nop 0
  buffer_load_dwordx4 v1, s[12:15], s36 offen offset:1024 sc1 lds
FR_24:
  s_add_u32 s36, s36, 221184
  s_waitcnt vmcnt(10)
  s_barrier
  s_add_u32 m0, s35, 139264
  s_cmp_ge_u32 s35, 4096
  buffer_load_dwordx4 v1, s[12:15], s36 offen offset:0 sc1 lds
  s_cbranch_scc1 FR_25
  s_nop 0
  buffer_load_dwordx4 v1, s[12:15], s36 offen offset:1024 sc1 lds
FR_25:
  s_add_u32 s36, s36, 221184
  s_add_u32 m0, s35, 155648
  s_cmp_ge_u32 s35, 4096
  buffer_load_dwordx4 v1, s[12:15], s36 offen offset:0 sc1 lds
  s_cbranch_scc1 FR_26
  s_nop 0
  buffer_load_dwordx4 v1, s[12:15], s36 offen offset:1024 sc1 lds
FR_26:
  s_add_u32 s36, s36, 221184
  s_waitcnt vmcnt(4)
  s_barrier
  s_add_u32 m0, s35, 8192
  s_cmp_ge_u32 s35, 4096
  buffer_load_dwordx4 v1, s[12:15], s36 offen offset:0 sc1 lds
  s_cbranch_scc1 FR_27
  s_nop 0
  buffer_load_dwordx4 v1, s[12:15], s36 offen offset:1024 sc1 lds
FR_27:
  s_add_u32 s36, s36, 221184
  s_add_u32 m0, s35, 24576
  s_cmp_ge_u32 s35, 4096
  buffer_load_dwordx4 v1, s[12:15], s36 offen offset:0 sc1 lds
  s_cbranch_scc1 FR_28
  s_nop 0
  buffer_load_dwordx4 v1, s[12:15], s36 offen offset:1024 sc1 lds
FR_28:
  s_add_u32 s36, s36, 221184
  s_waitcnt vmcnt(4)
  s_barrier
  s_add_u32 m0, s35, 40960
  s_cmp_ge_u32 s35, 4096
  buffer_load_dwordx4 v1, s[12:15], s36 offen offset:0 sc1 lds
  s_cbranch_scc1 FR_29
  s_nop 0
  buffer_load_dwordx4 v1, s[12:15], s36 offen offset:1024 sc1 lds
FR_29:
  s_add_u32 s36, s36, 221184
  s_add_u32 m0, s35, 57344
  s_cmp_ge_u32 s35, 4096
  buffer_load_dwordx4 v1, s[12:15], s36 offen offset:0 sc1 lds
  s_cbranch_scc1 FR_30
  s_nop 0
  buffer_load_dwordx4 v1, s[12:15], s36 offen offset:1024 sc1 lds
FR_30:
  s_add_u32 s36, s36, -4202496
  s_waitcnt vmcnt(4)
  s_barrier
  s_add_u32 m0, s33, 98304
  s_mov_b32 s89, 0x10000
  buffer_load_dwordx4 v1, s[12:15], s32 offen sc1 lds
  buffer_load_dwordx4 v1, s[12:15], s32 offen offset:1024 sc1 lds
  s_add_u32 s32, s32, 2048
  s_add_u32 m0, s33, 114688
  s_mov_b32 s89, 0x10000
  buffer_load_dwordx4 v1, s[12:15], s32 offen sc1 lds
  buffer_load_dwordx4 v1, s[12:15], s32 offen offset:1024 sc1 lds
  s_add_u32 s32, s32, 2048
  s_add_u32 m0, s35, 106496
  s_cmp_ge_u32 s35, 4096
  buffer_load_dwordx4 v1, s[12:15], s36 offen offset:0 sc1 lds
  s_cbranch_scc1 FR_31
  s_nop 0
  buffer_load_dwordx4 v1, s[12:15], s36 offen offset:1024 sc1 lds
FR_31:
  s_add_u32 s36, s36, 221184
  s_add_u32 m0, s35, 122880
  s_cmp_ge_u32 s35, 4096
  buffer_load_dwordx4 v1, s[12:15], s36 offen offset:0 sc1 lds
  s_cbranch_scc1 FR_32
  s_nop 0
  buffer_load_dwordx4 v1, s[12:15], s36 offen offset:1024 sc1 lds
FR_32:
  s_add_u32 s36, s36, 221184
  s_waitcnt vmcnt(8)
  s_barrier
  s_add_u32 m0, s33, 131072
  s_mov_b32 s89, 0x10000
  buffer_load_dwordx4 v1, s[12:15], s32 offen sc1 lds
  buffer_load_dwordx4 v1, s[12:15], s32 offen offset:1024 sc1 lds
  s_add_u32 s32, s32, 2048
  s_add_u32 m0, s33, 147456
  s_mov_b32 s89, 0x10000
  buffer_load_dwordx4 v1, s[12:15], s32 offen sc1 lds
  buffer_load_dwordx4 v1, s[12:15], s32 offen offset:1024 sc1 lds
  s_add_u32 s32, s32, 2048
  s_add_u32 m0, s35, 139264
  s_cmp_ge_u32 s35, 4096
  buffer_load_dwordx4 v1, s[12:15], s36 offen offset:0 sc1 lds
  s_cbranch_scc1 FR_33
  s_nop 0
  buffer_load_dwordx4 v1, s[12:15], s36 offen offset:1024 sc1 lds
FR_33:
  s_add_u32 s36, s36, 221184
  s_add_u32 m0, s35, 155648
  s_cmp_ge_u32 s35, 4096
  buffer_load_dwordx4 v1, s[12:15], s36 offen offset:0 sc1 lds
  s_cbranch_scc1 FR_34
  s_nop 0
  buffer_load_dwordx4 v1, s[12:15], s36 offen offset:1024 sc1 lds
FR_34:
  s_add_u32 s36, s36, 221184
  s_cmp_lg_u32 s16, 0
  s_cbranch_scc1 FL_35
  s_lshl_b32 s34, s43, 4
  s_add_u32 s34, s34, s3
  s_lshl_b32 s34, s34, 7
  s_add_u32 s34, s34, 23789568
  v_mov_b32 v2, s54
  v_mov_b32_e64 v3, s34
  s_mov_b64 exec, 1
  buffer_store_dword v2, v3, s[12:15], 0 offen sc1
  s_mov_b64 exec, -1
FL_35:
  s_waitcnt vmcnt(12)
  s_barrier
  s_and_b32 m0, s33, 0xfffff
  s_mov_b32 s89, 0x10000
  buffer_load_dwordx4 v1, s[12:15], s32 offen sc1 lds
  buffer_load_dwordx4 v1, s[12:15], s32 offen offset:1024 sc1 lds
  s_add_u32 s32, s32, 2048
  s_add_u32 m0, s33, 16384
  s_mov_b32 s89, 0x10000
  buffer_load_dwordx4 v1, s[12:15], s32 offen sc1 lds
  buffer_load_dwordx4 v1, s[12:15], s32 offen offset:1024 sc1 lds
  s_add_u32 s32, s32, 2048
  s_add_u32 m0, s35, 8192
  s_cmp_ge_u32 s35, 4096
  buffer_load_dwordx4 v1, s[12:15], s36 offen offset:0 sc1 lds
  s_cbranch_scc1 FR_36
  s_nop 0
  buffer_load_dwordx4 v1, s[12:15], s36 offen offset:1024 sc1 lds
FR_36:
  s_add_u32 s36, s36, 221184
  s_add_u32 m0, s35, 24576
  s_cmp_ge_u32 s35, 4096
  buffer_load_dwordx4 v1, s[12:15], s36 offen offset:0 sc1 lds
  s_cbranch_scc1 FR_37
  s_nop 0
  buffer_load_dwordx4 v1, s[12:15], s36 offen offset:1024 sc1 lds
FR_37:
  s_add_u32 s36, s36, 221184
  s_waitcnt vmcnt(12)
  s_barrier
  s_add_u32 m0, s33, 32768
  s_mov_b32 s89, 0x10000
  buffer_load_dwordx4 v1, s[12:15], s32 offen sc1 lds
  buffer_load_dwordx4 v1, s[12:15], s32 offen offset:1024 sc1 lds
  s_add_u32 s32, s32, 2048
  s_add_u32 m0, s33, 49152
  s_mov_b32 s89, 0x10000
  buffer_load_dwordx4 v1, s[12:15], s32 offen sc1 lds
  buffer_load_dwordx4 v1, s[12:15], s32 offen offset:1024 sc1 lds
  s_add_u32 s32, s32, 2048
  s_add_u32 m0, s35, 40960
  s_cmp_ge_u32 s35, 4096
  buffer_load_dwordx4 v1, s[12:15], s36 offen offset:0 sc1 lds
  s_cbranch_scc1 FR_38
  s_nop 0
  buffer_load_dwordx4 v1, s[12:15], s36 offen offset:1024 sc1 lds
FR_38:
  s_add_u32 s36, s36, 221184
  s_add_u32 m0, s35, 57344
  s_cmp_ge_u32 s35, 4096
  buffer_load_dwordx4 v1, s[12:15], s36 offen offset:0 sc1 lds
  s_cbranch_scc1 FR_39
  s_nop 0
  buffer_load_dwordx4 v1, s[12:15], s36 offen offset:1024 sc1 lds
FR_39:
  s_add_u32 s36, s36, 221184
  s_waitcnt vmcnt(12)
  s_barrier
  s_add_u32 m0, s33, 98304
  s_mov_b32 s89, 0x10000
  buffer_load_dwordx4 v1, s[12:15], s32 offen sc1 lds
  buffer_load_dwordx4 v1, s[12:15], s32 offen offset:1024 sc1 lds
  s_add_u32 s32, s32, 2048
  s_add_u32 m0, s33, 114688
  s_mov_b32 s89, 0x10000
  buffer_load_dwordx4 v1, s[12:15], s32 offen sc1 lds
  buffer_load_dwordx4 v1, s[12:15], s32 offen offset:1024 sc1 lds
  s_add_u32 s32, s32, 2048
  s_add_u32 m0, s35, 106496
  s_cmp_ge_u32 s35, 4096
  buffer_load_dwordx4 v1, s[12:15], s36 offen offset:0 sc1 lds
  s_cbranch_scc1 FR_40
  s_nop 0
  buffer_load_dwordx4 v1, s[12:15], s36 offen offset:1024 sc1 lds
FR_40:
  s_add_u32 s36, s36, 221184
  s_add_u32 m0, s35, 122880
  s_cmp_ge_u32 s35, 4096
  buffer_load_dwordx4 v1, s[12:15], s36 offen offset:0 sc1 lds
  s_cbranch_scc1 FR_41
  s_nop 0
  buffer_load_dwordx4 v1, s[12:15], s36 offen offset:1024 sc1 lds
FR_41:
  s_add_u32 s36, s36, 221184
  s_waitcnt vmcnt(12)
  s_barrier
  s_add_u32 m0, s33, 131072
  s_mov_b32 s89, 0x10000
  buffer_load_dwordx4 v1, s[12:15], s32 offen sc1 lds
  buffer_load_dwordx4 v1, s[12:15], s32 offen offset:1024 sc1 lds
  s_add_u32 s32, s32, 2048
  s_add_u32 m0, s33, 147456
  s_mov_b32 s89, 0x10000
  buffer_load_dwordx4 v1, s[12:15], s32 offen sc1 lds
  buffer_load_dwordx4 v1, s[12:15], s32 offen offset:1024 sc1 lds
  s_add_u32 s32, s32, 2048
  s_add_u32 m0, s35, 139264
  s_cmp_ge_u32 s35, 4096
  buffer_load_dwordx4 v1, s[12:15], s36 offen offset:0 sc1 lds
  s_cbranch_scc1 FR_42
  s_nop 0
  buffer_load_dwordx4 v1, s[12:15], s36 offen offset:1024 sc1 lds
FR_42:
  s_add_u32 s36, s36, 221184
  s_add_u32 m0, s35, 155648
  s_cmp_ge_u32 s35, 4096
  buffer_load_dwordx4 v1, s[12:15], s36 offen offset:0 sc1 lds
  s_cbranch_scc1 FR_43
  s_nop 0
  buffer_load_dwordx4 v1, s[12:15], s36 offen offset:1024 sc1 lds
FR_43:
  s_add_u32 s36, s36, 221184
  s_lshr_b32 s37, s40, 1
  s_lshl_b32 s37, s37, 11
  s_add_u32 s37, s37, 23789568
  buffer_load_dword v16, v8, s[12:15], s37 offen sc1
  s_mul_i32 s35, s16, 2
  s_min_u32 s34, s16, 2
  s_add_u32 s35, s35, s34
  s_lshl_b32 s35, s35, 10
  s_mul_i32 s36, s41, 378880
  s_add_u32 s36, s36, s35
  s_add_u32 s36, s36, 30511104
  s_lshl_b32 s32, s40, 1
  s_lshr_b32 s33, s16, 1
  s_add_u32 s32, s32, s33
  s_mul_i32 s32, s32, 110592
  s_and_b32 s33, s16, 1
  s_lshl_b32 s33, s33, 11
  s_add_u32 s32, s32, s33
  s_add_u32 s32, s32, 15728640
  s_lshl_b32 s33, s16, 11
  s_add_u32 s33, s33, 98304
  s_waitcnt vmcnt(13)
  s_barrier
  s_and_b32 m0, s35, 0xfffff
  s_cmp_ge_u32 s35, 6144
  buffer_load_dwordx4 v1, s[12:15], s36 offen offset:0 sc1 lds
  buffer_load_dwordx4 v1, s[12:15], s36 offen offset:1024 sc1 lds
  s_cbranch_scc1 FR_44
  s_nop 0
  buffer_load_dwordx4 v1, s[12:15], s36 offen offset:2048 sc1 lds
FR_44:
  s_add_u32 s36, s36, 10240
  s_add_u32 m0, s35, 10240
  s_cmp_ge_u32 s35, 6144
  buffer_load_dwordx4 v1, s[12:15], s36 offen offset:0 sc1 lds
  buffer_load_dwordx4 v1, s[12:15], s36 offen offset:1024 sc1 lds
  s_cbranch_scc1 FR_45
  s_nop 0
  buffer_load_dwordx4 v1, s[12:15], s36 offen offset:2048 sc1 lds
FR_45:
  s_add_u32 s36, s36, 10240
  s_add_u32 m0, s35, 20480
  s_cmp_ge_u32 s35, 6144
  buffer_load_dwordx4 v1, s[12:15], s36 offen offset:0 sc1 lds
  buffer_load_dwordx4 v1, s[12:15], s36 offen offset:1024 sc1 lds
  s_cbranch_scc1 FR_46
  s_nop 0
  buffer_load_dwordx4 v1, s[12:15], s36 offen offset:2048 sc1 lds
FR_46:
  s_add_u32 s36, s36, 10240
  s_waitcnt vmcnt(13)
  s_barrier
  s_waitcnt vmcnt(7)
  s_barrier
  s_waitcnt vmcnt(6)
  v_cmp_ne_u32 vcc, s54, v16
  s_nop 4
  s_cbranch_vccz CK_2476
  s_mov_b32 s39, 0
POLL_47_P:
  s_add_u32 s39, s39, 1
  s_cmp_gt_u32 s39, 400000
  s_cbranch_scc1 POLL_47_X
  buffer_load_dword v16, v8, s[12:15], s37 offen sc1
  s_waitcnt vmcnt(0)
  v_cmp_ne_u32 vcc, s54, v16
  s_nop 4
  s_cbranch_vccnz POLL_47_P
POLL_47_X:
  s_mov_b64 exec, -1
POLL_47_Q:
CK_2476:
  s_and_b32 m0, s33, 0xfffff
  s_mov_b32 s89, 0x10000
  buffer_load_dwordx4 v1, s[12:15], s32 offen sc1 lds
  buffer_load_dwordx4 v1, s[12:15], s32 offen offset:1024 sc1 lds
  s_add_u32 s32, s32, 4096
  s_add_u32 m0, s33, 8192
  s_mov_b32 s89, 0x10000
  buffer_load_dwordx4 v1, s[12:15], s32 offen sc1 lds
  buffer_load_dwordx4 v1, s[12:15], s32 offen offset:1024 sc1 lds
  s_add_u32 s32, s32, 4096
  s_add_u32 m0, s33, 16384
  s_mov_b32 s89, 0x10000
  buffer_load_dwordx4 v1, s[12:15], s32 offen sc1 lds
  buffer_load_dwordx4 v1, s[12:15], s32 offen offset:1024 sc1 lds
  s_add_u32 s32, s32, 4096
  s_add_u32 m0, s33, 24576
  s_mov_b32 s89, 0x10000
  buffer_load_dwordx4 v1, s[12:15], s32 offen sc1 lds
  buffer_load_dwordx4 v1, s[12:15], s32 offen offset:1024 sc1 lds
  s_add_u32 s32, s32, 4096
  s_add_u32 m0, s35, 30720
  s_cmp_ge_u32 s35, 6144
  buffer_load_dwordx4 v1, s[12:15], s36 offen offset:0 sc1 lds
  buffer_load_dwordx4 v1, s[12:15], s36 offen offset:1024 sc1 lds
  s_cbranch_scc1 FR_48
  s_nop 0
  buffer_load_dwordx4 v1, s[12:15], s36 offen offset:2048 sc1 lds
FR_48:
  s_add_u32 s36, s36, 10240
  s_add_u32 m0, s35, 40960
  s_cmp_ge_u32 s35, 6144
  buffer_load_dwordx4 v1, s[12:15], s36 offen offset:0 sc1 lds
  buffer_load_dwordx4 v1, s[12:15], s36 offen offset:1024 sc1 lds
  s_cbranch_scc1 FR_49
  s_nop 0
  buffer_load_dwordx4 v1, s[12:15], s36 offen offset:2048 sc1 lds
FR_49:
  s_add_u32 s36, s36, 10240
  s_add_u32 m0, s35, 51200
  s_cmp_ge_u32 s35, 6144
  buffer_load_dwordx4 v1, s[12:15], s36 offen offset:0 sc1 lds
  buffer_load_dwordx4 v1, s[12:15], s36 offen offset:1024 sc1 lds
  s_cbranch_scc1 FR_50
  s_nop 0
  buffer_load_dwordx4 v1, s[12:15], s36 offen offset:2048 sc1 lds
FR_50:
  s_add_u32 s36, s36, 10240
  s_add_u32 m0, s35, 61440
  s_cmp_ge_u32 s35, 6144
  buffer_load_dwordx4 v1, s[12:15], s36 offen offset:0 sc1 lds
  buffer_load_dwordx4 v1, s[12:15], s36 offen offset:1024 sc1 lds
  s_cbranch_scc1 FR_51
  s_nop 0
  buffer_load_dwordx4 v1, s[12:15], s36 offen offset:2048 sc1 lds
FR_51:
  s_add_u32 s36, s36, 10240
  s_add_u32 m0, s35, 71680
  s_cmp_ge_u32 s35, 6144
  buffer_load_dwordx4 v1, s[12:15], s36 offen offset:0 sc1 lds
  buffer_load_dwordx4 v1, s[12:15], s36 offen offset:1024 sc1 lds
  s_cbranch_scc1 FR_52
  s_nop 0
  buffer_load_dwordx4 v1, s[12:15], s36 offen offset:2048 sc1 lds
FR_52:
  s_add_u32 s36, s36, 10240
  s_waitcnt vmcnt(16)
  s_barrier
  s_add_u32 m0, s33, 32768
  s_mov_b32 s89, 0x10000
  buffer_load_dwordx4 v1, s[12:15], s32 offen sc1 lds
  buffer_load_dwordx4 v1, s[12:15], s32 offen offset:1024 sc1 lds
  s_add_u32 s32, s32, 4096
  s_add_u32 m0, s33, 40960
  s_mov_b32 s89, 0x10000
  buffer_load_dwordx4 v1, s[12:15], s32 offen sc1 lds
  buffer_load_dwordx4 v1, s[12:15], s32 offen offset:1024 sc1 lds
  s_add_u32 s32, s32, 4096
  s_waitcnt vmcnt(18)
  s_barrier
  s_add_u32 m0, s33, 49152
  s_mov_b32 s89, 0x10000
  buffer_load_dwordx4 v1, s[12:15], s32 offen sc1 lds
  buffer_load_dwordx4 v1, s[12:15], s32 offen offset:1024 sc1 lds
  s_add_u32 s32, s32, 4096
  s_add_u32 m0, s33, 57344
  s_mov_b32 s89, 0x10000
  buffer_load_dwordx4 v1, s[12:15], s32 offen sc1 lds
  buffer_load_dwordx4 v1, s[12:15], s32 offen offset:1024 sc1 lds
  s_add_u32 s32, s32, 4096
  s_waitcnt vmcnt(20)
  s_barrier
  s_and_b32 m0, s33, 0xfffff
  s_mov_b32 s89, 0x10000
  buffer_load_dwordx4 v1, s[12:15], s32 offen sc1 lds
  buffer_load_dwordx4 v1, s[12:15], s32 offen offset:1024 sc1 lds
  s_add_u32 s32, s32, 4096
  s_and_b32 m0, s35, 0xfffff
  s_cmp_ge_u32 s35, 6144
  buffer_load_dwordx4 v1, s[12:15], s36 offen offset:0 sc1 lds
  buffer_load_dwordx4 v1, s[12:15], s36 offen offset:1024 sc1 lds
  s_cbranch_scc1 FR_53
  s_nop 0
  buffer_load_dwordx4 v1, s[12:15], s36 offen offset:2048 sc1 lds
FR_53:
  s_add_u32 s36, s36, 10240
  s_waitcnt vmcnt(20)
  s_barrier
  s_add_u32 m0, s33, 8192
  s_mov_b32 s89, 0x10000
  buffer_load_dwordx4 v1, s[12:15], s32 offen sc1 lds
  buffer_load_dwordx4 v1, s[12:15], s32 offen offset:1024 sc1 lds
  s_add_u32 s32, s32, 4096
  s_add_u32 m0, s35, 10240
  s_cmp_ge_u32 s35, 6144
  buffer_load_dwordx4 v1, s[12:15], s36 offen offset:0 sc1 lds
  buffer_load_dwordx4 v1, s[12:15], s36 offen offset:1024 sc1 lds
  s_cbranch_scc1 FR_54
  s_nop 0
  buffer_load_dwordx4 v1, s[12:15], s36 offen offset:2048 sc1 lds
FR_54:
  s_add_u32 s36, s36, 10240
  s_waitcnt vmcnt(14)
  s_barrier
  s_cmp_lg_u32 s16, 0
  s_cbranch_scc1 FL_55
  s_lshl_b32 s34, s43, 4
  s_add_u32 s34, s34, s3
  s_lshl_b32 s34, s34, 7
  s_add_u32 s34, s34, 23920640
  v_mov_b32 v2, s54
  v_mov_b32_e64 v3, s34
  s_mov_b64 exec, 1
  buffer_store_dword v2, v3, s[12:15], 0 offen sc1
  s_mov_b64 exec, -1
FL_55:
  s_add_u32 m0, s33, 16384
  s_mov_b32 s89, 0x10000
  buffer_load_dwordx4 v1, s[12:15], s32 offen sc1 lds
  buffer_load_dwordx4 v1, s[12:15], s32 offen offset:1024 sc1 lds
  s_add_u32 s32, s32, 4096
  s_add_u32 m0, s35, 20480
  s_cmp_ge_u32 s35, 6144
  buffer_load_dwordx4 v1, s[12:15], s36 offen offset:0 sc1 lds
  buffer_load_dwordx4 v1, s[12:15], s36 offen offset:1024 sc1 lds
  s_cbranch_scc1 FR_56
  s_nop 0
  buffer_load_dwordx4 v1, s[12:15], s36 offen offset:2048 sc1 lds
FR_56:
  s_add_u32 s36, s36, 10240
  s_waitcnt vmcnt(16)
  s_barrier
  s_add_u32 m0, s33, 24576
  s_mov_b32 s89, 0x10000
  buffer_load_dwordx4 v1, s[12:15], s32 offen sc1 lds
  buffer_load_dwordx4 v1, s[12:15], s32 offen offset:1024 sc1 lds
  s_add_u32 s32, s32, 4096
  s_add_u32 m0, s35, 30720
  s_cmp_ge_u32 s35, 6144
  buffer_load_dwordx4 v1, s[12:15], s36 offen offset:0 sc1 lds
  buffer_load_dwordx4 v1, s[12:15], s36 offen offset:1024 sc1 lds
  s_cbranch_scc1 FR_57
  s_nop 0
  buffer_load_dwordx4 v1, s[12:15], s36 offen offset:2048 sc1 lds
FR_57:
  s_add_u32 s36, s36, 10240
  s_waitcnt vmcnt(18)
  s_barrier
  s_add_u32 m0, s33, 32768
  s_mov_b32 s89, 0x10000
  buffer_load_dwordx4 v1, s[12:15], s32 offen sc1 lds
  buffer_load_dwordx4 v1, s[12:15], s32 offen offset:1024 sc1 lds
  s_add_u32 s32, s32, 4096
  s_add_u32 m0, s35, 40960
  s_cmp_ge_u32 s35, 6144
  buffer_load_dwordx4 v1, s[12:15], s36 offen offset:0 sc1 lds
  buffer_load_dwordx4 v1, s[12:15], s36 offen offset:1024 sc1 lds
  s_cbranch_scc1 FR_58
  s_nop 0
  buffer_load_dwordx4 v1, s[12:15], s36 offen offset:2048 sc1 lds
FR_58:
  s_add_u32 s36, s36, 10240
  s_waitcnt vmcnt(20)
  s_barrier
  s_add_u32 m0, s33, 40960
  s_mov_b32 s89, 0x10000
  buffer_load_dwordx4 v1, s[12:15], s32 offen sc1 lds
  buffer_load_dwordx4 v1, s[12:15], s32 offen offset:1024 sc1 lds
  s_add_u32 s32, s32, 4096
  s_add_u32 m0, s35, 51200
  s_cmp_ge_u32 s35, 6144
  buffer_load_dwordx4 v1, s[12:15], s36 offen offset:0 sc1 lds
  buffer_load_dwordx4 v1, s[12:15], s36 offen offset:1024 sc1 lds
  s_cbranch_scc1 FR_59
  s_nop 0
  buffer_load_dwordx4 v1, s[12:15], s36 offen offset:2048 sc1 lds
FR_59:
  s_add_u32 s36, s36, 10240
  s_waitcnt vmcnt(20)
  s_barrier
  s_add_u32 m0, s33, 49152
  s_mov_b32 s89, 0x10000
  buffer_load_dwordx4 v1, s[12:15], s32 offen sc1 lds
  buffer_load_dwordx4 v1, s[12:15], s32 offen offset:1024 sc1 lds
  s_add_u32 s32, s32, 4096
  s_add_u32 m0, s35, 61440
  s_cmp_ge_u32 s35, 6144
  buffer_load_dwordx4 v1, s[12:15], s36 offen offset:0 sc1 lds
  buffer_load_dwordx4 v1, s[12:15], s36 offen offset:1024 sc1 lds
  s_cbranch_scc1 FR_60
  s_nop 0
  buffer_load_dwordx4 v1, s[12:15], s36 offen offset:2048 sc1 lds
FR_60:
  s_add_u32 s36, s36, 10240
  s_waitcnt vmcnt(20)
  s_barrier
  s_add_u32 m0, s33, 57344
  s_mov_b32 s89, 0x10000
  buffer_load_dwordx4 v1, s[12:15], s32 offen sc1 lds
  buffer_load_dwordx4 v1, s[12:15], s32 offen offset:1024 sc1 lds
  s_add_u32 s32, s32, 4096
  s_add_u32 m0, s35, 71680
  s_cmp_ge_u32 s35, 6144
  buffer_load_dwordx4 v1, s[12:15], s36 offen offset:0 sc1 lds
  buffer_load_dwordx4 v1, s[12:15], s36 offen offset:1024 sc1 lds
  s_cbranch_scc1 FR_61
  s_nop 0
  buffer_load_dwordx4 v1, s[12:15], s36 offen offset:2048 sc1 lds
FR_61:
  s_add_u32 s36, s36, 10240
  s_waitcnt vmcnt(20)
  s_barrier
  s_and_b32 m0, s35, 0xfffff
  s_cmp_ge_u32 s35, 6144
  buffer_load_dwordx4 v1, s[12:15], s36 offen offset:0 sc1 lds
  buffer_load_dwordx4 v1, s[12:15], s36 offen offset:1024 sc1 lds
  s_cbranch_scc1 FR_62
  s_nop 0
  buffer_load_dwordx4 v1, s[12:15], s36 offen offset:2048 sc1 lds
FR_62:
  s_add_u32 s36, s36, 10240
  s_waitcnt vmcnt(18)
  s_barrier
  s_add_u32 m0, s35, 10240
  s_cmp_ge_u32 s35, 6144
  buffer_load_dwordx4 v1, s[12:15], s36 offen offset:0 sc1 lds
  buffer_load_dwordx4 v1, s[12:15], s36 offen offset:1024 sc1 lds
  s_cbranch_scc1 FR_63
  s_nop 0
  buffer_load_dwordx4 v1, s[12:15], s36 offen offset:2048 sc1 lds
FR_63:
  s_add_u32 s36, s36, 10240
  s_waitcnt vmcnt(16)
  s_barrier
  s_and_b32 m0, s33, 0xfffff
  s_mov_b32 s89, 0x10000
  buffer_load_dwordx4 v1, s[12:15], s32 offen sc1 lds
  buffer_load_dwordx4 v1, s[12:15], s32 offen offset:1024 sc1 lds
  s_add_u32 s32, s32, 4096
  s_add_u32 m0, s33, 8192
  s_mov_b32 s89, 0x10000
  buffer_load_dwordx4 v1, s[12:15], s32 offen sc1 lds
  buffer_load_dwordx4 v1, s[12:15], s32 offen offset:1024 sc1 lds
  s_add_u32 s32, s32, 4096
  s_add_u32 m0, s33, 16384
  s_mov_b32 s89, 0x10000
  buffer_load_dwordx4 v1, s[12:15], s32 offen sc1 lds
  buffer_load_dwordx4 v1, s[12:15], s32 offen offset:1024 sc1 lds
  s_add_u32 s32, s32, 4096
  s_add_u32 m0, s35, 20480
  s_cmp_ge_u32 s35, 6144
  buffer_load_dwordx4 v1, s[12:15], s36 offen offset:0 sc1 lds
  buffer_load_dwordx4 v1, s[12:15], s36 offen offset:1024 sc1 lds
  s_cbranch_scc1 FR_64
  s_nop 0
  buffer_load_dwordx4 v1, s[12:15], s36 offen offset:2048 sc1 lds
FR_64:
  s_add_u32 s36, s36, 10240
  s_waitcnt vmcnt(20)
  s_barrier
  s_add_u32 m0, s33, 24576
  s_mov_b32 s89, 0x10000
  buffer_load_dwordx4 v1, s[12:15], s32 offen sc1 lds
  buffer_load_dwordx4 v1, s[12:15], s32 offen offset:1024 sc1 lds
  s_add_u32 s32, s32, 4096
  s_add_u32 m0, s35, 30720
  s_cmp_ge_u32 s35, 6144
  buffer_load_dwordx4 v1, s[12:15], s36 offen offset:0 sc1 lds
  buffer_load_dwordx4 v1, s[12:15], s36 offen offset:1024 sc1 lds
  s_cbranch_scc1 FR_65
  s_nop 0
  buffer_load_dwordx4 v1, s[12:15], s36 offen offset:2048 sc1 lds
FR_65:
  s_add_u32 s36, s36, 10240
  s_waitcnt vmcnt(20)
  s_barrier
  s_add_u32 m0, s33, 32768
  s_mov_b32 s89, 0x10000
  buffer_load_dwordx4 v1, s[12:15], s32 offen sc1 lds
  buffer_load_dwordx4 v1, s[12:15], s32 offen offset:1024 sc1 lds
  s_add_u32 s32, s32, 4096
  s_add_u32 m0, s35, 40960
  s_cmp_ge_u32 s35, 6144
  buffer_load_dwordx4 v1, s[12:15], s36 offen offset:0 sc1 lds
  buffer_load_dwordx4 v1, s[12:15], s36 offen offset:1024 sc1 lds
  s_cbranch_scc1 FR_66
  s_nop 0
  buffer_load_dwordx4 v1, s[12:15], s36 offen offset:2048 sc1 lds
FR_66:
  s_add_u32 s36, s36, 10240
  s_waitcnt vmcnt(20)
  s_barrier
  s_add_u32 m0, s33, 40960
  s_mov_b32 s89, 0x10000
  buffer_load_dwordx4 v1, s[12:15], s32 offen sc1 lds
  buffer_load_dwordx4 v1, s[12:15], s32 offen offset:1024 sc1 lds
  s_add_u32 s32, s32, 4096
  s_add_u32 m0, s35, 51200
  s_cmp_ge_u32 s35, 6144
  buffer_load_dwordx4 v1, s[12:15], s36 offen offset:0 sc1 lds
  buffer_load_dwordx4 v1, s[12:15], s36 offen offset:1024 sc1 lds
  s_cbranch_scc1 FR_67
  s_nop 0
  buffer_load_dwordx4 v1, s[12:15], s36 offen offset:2048 sc1 lds
FR_67:
  s_add_u32 s36, s36, 10240
  s_waitcnt vmcnt(18)
  s_barrier
  s_add_u32 m0, s33, 49152
  s_mov_b32 s89, 0x10000
  buffer_load_dwordx4 v1, s[12:15], s32 offen sc1 lds
  buffer_load_dwordx4 v1, s[12:15], s32 offen offset:1024 sc1 lds
  s_add_u32 s32, s32, 4096
  s_add_u32 m0, s35, 61440
  s_cmp_ge_u32 s35, 6144
  buffer_load_dwordx4 v1, s[12:15], s36 offen offset:0 sc1 lds
  buffer_load_dwordx4 v1, s[12:15], s36 offen offset:1024 sc1 lds
  s_cbranch_scc1 FR_68
  s_nop 0
  buffer_load_dwordx4 v1, s[12:15], s36 offen offset:2048 sc1 lds
FR_68:
  s_add_u32 s36, s36, 10240
  s_waitcnt vmcnt(20)
  s_barrier
  s_add_u32 m0, s33, 57344
  s_mov_b32 s89, 0x10000
  buffer_load_dwordx4 v1, s[12:15], s32 offen sc1 lds
  buffer_load_dwordx4 v1, s[12:15], s32 offen offset:1024 sc1 lds
  s_add_u32 s32, s32, 4096
  s_add_u32 m0, s35, 71680
  s_cmp_ge_u32 s35, 6144
  buffer_load_dwordx4 v1, s[12:15], s36 offen offset:0 sc1 lds
  buffer_load_dwordx4 v1, s[12:15], s36 offen offset:1024 sc1 lds
  s_cbranch_scc1 FR_69
  s_nop 0
  buffer_load_dwordx4 v1, s[12:15], s36 offen offset:2048 sc1 lds
FR_69:
  s_add_u32 s36, s36, 10240
  s_waitcnt vmcnt(20)
  s_barrier
  s_and_b32 m0, s33, 0xfffff
  s_mov_b32 s89, 0x10000
  buffer_load_dwordx4 v1, s[12:15], s32 offen sc1 lds
  buffer_load_dwordx4 v1, s[12:15], s32 offen offset:1024 sc1 lds
  s_add_u32 s32, s32, 4096
  s_and_b32 m0, s35, 0xfffff
  s_cmp_ge_u32 s35, 6144
  buffer_load_dwordx4 v1, s[12:15], s36 offen offset:0 sc1 lds
  buffer_load_dwordx4 v1, s[12:15], s36 offen offset:1024 sc1 lds
  s_cbranch_scc1 FR_70
  s_nop 0
  buffer_load_dwordx4 v1, s[12:15], s36 offen offset:2048 sc1 lds
FR_70:
  s_add_u32 s36, s36, 10240
  s_waitcnt vmcnt(20)
  s_barrier
  s_add_u32 m0, s33, 8192
  s_mov_b32 s89, 0x10000
  buffer_load_dwordx4 v1, s[12:15], s32 offen sc1 lds
  buffer_load_dwordx4 v1, s[12:15], s32 offen offset:1024 sc1 lds
  s_add_u32 s32, s32, 4096
  s_add_u32 m0, s35, 10240
  s_cmp_ge_u32 s35, 6144
  buffer_load_dwordx4 v1, s[12:15], s36 offen offset:0 sc1 lds
  buffer_load_dwordx4 v1, s[12:15], s36 offen offset:1024 sc1 lds
  s_cbranch_scc1 FR_71
  s_nop 0
  buffer_load_dwordx4 v1, s[12:15], s36 offen offset:2048 sc1 lds
FR_71:
  s_add_u32 s36, s36, 10240
  s_waitcnt vmcnt(20)
  s_barrier
  s_add_u32 m0, s33, 16384
  s_mov_b32 s89, 0x10000
  buffer_load_dwordx4 v1, s[12:15], s32 offen sc1 lds
  buffer_load_dwordx4 v1, s[12:15], s32 offen offset:1024 sc1 lds
  s_add_u32 s32, s32, 4096
  s_add_u32 m0, s35, 20480
  s_cmp_ge_u32 s35, 6144
  buffer_load_dwordx4 v1, s[12:15], s36 offen offset:0 sc1 lds
  buffer_load_dwordx4 v1, s[12:15], s36 offen offset:1024 sc1 lds
  s_cbranch_scc1 FR_72
  s_nop 0
  buffer_load_dwordx4 v1, s[12:15], s36 offen offset:2048 sc1 lds
FR_72:
  s_add_u32 s36, s36, 10240
  s_waitcnt vmcnt(20)
  s_barrier
  s_waitcnt vmcnt(16)
  s_barrier
  s_waitcnt vmcnt(12)
  s_barrier
  s_waitcnt vmcnt(8)
  s_barrier
  s_waitcnt vmcnt(4)
  s_barrier
  s_waitcnt vmcnt(0)
  s_barrier
  s_endpgm
K2_COMP:
  s_load_dwordx2 s[22:23], s[0:1], 16
  s_load_dwordx4 s[28:31], s[0:1], 40
  s_load_dwordx2 s[26:27], s[0:1], 32
  s_load_dwordx2 s[46:47], s[0:1], 56
  s_and_b32 s17, s2, 7
  s_lshl_b32 s17, s17, 2
  s_bfe_u32 s18, s2, 0x20003
  s_add_u32 s17, s17, s18
  s_lshr_b32 s18, s2, 5
  s_bfe_u32 s40, s2, 0x20001
  s_lshl_b32 s40, s40, 3
  s_bfe_u32 s41, s2, 0x30003
  s_add_u32 s40, s40, s41
  s_bfe_u32 s43, s2, 0x10002
  s_lshl_b32 s43, s43, 3
  s_add_u32 s43, s43, s41
  s_and_b32 s41, s2, 1
  s_lshl_b32 s41, s41, 2
  s_lshr_b32 s42, s2, 6
  s_add_u32 s41, s41, s42
  s_and_b32 s44, s2, 3
  s_lshl_b32 s44, s44, 2
  s_add_u32 s44, s44, s42
  s_mov_b32 s3, s44
  s_mul_i32 s44, s44, 3
  s_min_u32 s44, s44, 41
  s_add_u32 s44, s44, 64
  s_mul_i32 s42, s41, 160
  s_and_b32 s42, s42, 0xffc0
  v_and_b32 v8, 31, v0
  v_lshrrev_b32 v9, 5, v0
  v_lshlrev_b32 v12, 4, v0
  v_lshlrev_b32 v10, 3, v8
  s_and_b32 s19, s16, 3
  s_lshr_b32 s32, s16, 2
  s_and_b32 s6, s16, 1
  s_lshl_b32 s6, s6, 1
  s_add_u32 s6, s6, s32
  s_bfe_u32 s7, s16, 0x10001
  s_xor_b32 s7, s7, s32
  s_lshl_b32 s33, s18, 2
  s_add_u32 s33, s33, s19
  s_lshl_b32 s33, s33, 1
  s_mul_i32 s34, s17, 81920
  s_lshr_b32 s35, s33, 2
  s_mul_i32 s35, s35, 5120
  s_add_u32 s34, s34, s35
  s_and_b32 s35, s33, 2
  s_lshl_b32 s36, s35, 8
  s_lshl_b32 s35, s35, 10
  s_add_u32 s4, s35, s34
  s_add_u32 s5, s36, s34
  s_add_u32 s5, s5, 4096
  s_waitcnt lgkmcnt(0)
  v_add_u32 v13, 102400, v12
  v_add_u32 v14, 106496, v10
  v_mul_u32_u24 v15, 16, v9
  v_lshl_add_u32 v15, v8, 5, v15
  s_mul_i32 s37, s32, 10240
  s_add_u32 s38, s37, 107520
  v_add_u32 v15, s38, v15
  v_mov_b32 v16, 0xdddd
  s_mov_b32 s48, 1048575
  s_mov_b32 s49, 1048575
  s_mov_b32 s50, -40960
  s_mov_b32 s51, 20480
  s_movk_i32 s52, 2560
  v_cmp_gt_u32 vcc, 20, v8
  v_mov_b32 v11, 99344
  v_sub_u32 v17, 1, v9
  v_cndmask_b32 v15, v11, v15, vcc
  v_cndmask_b32 v18, 0, 1, vcc
  v_cmp_lt_u32 vcc, 20, v8
  v_mov_b32 v11, 0x30000
  v_mul_u32_u24 v128, 640, v0
  v_cndmask_b32 v15, v15, v11, vcc
  v_cmp_eq_u32 vcc, 1, v9
  v_mov_b32 v11, 99328
  v_add_u32 v128, 99344, v128
  v_cndmask_b32 v14, v14, v11, vcc
  v_lshl_add_u32 v129, v0, 8, v11
  v_mov_b32 v136, 0x3f80
  v_mov_b32 v137, 0
  v_mov_b32 v140, 0x3f803f80
  v_mov_b32 v152, 0
  v_mov_b32 v141, 0x3f803f80
  v_mov_b32 v153, 0
  v_mov_b32 v142, 0x3f803f80
  v_mov_b32 v154, 0
  v_mov_b32 v143, 0x3f803f80
  v_mov_b32 v155, 0
  s_mov_b64 exec, 15
  ds_write_b128 v128, v[140:143]
  ds_write_b64 v129, v[136:137]
  s_mov_b64 exec, -1
  v_mov_b32 v96, 0
  v_mov_b32 v97, 0
  v_mov_b32 v98, 0
  v_mov_b32 v99, 0
  v_mov_b32 v100, 0
  v_mov_b32 v101, 0
  v_mov_b32 v102, 0
  v_mov_b32 v103, 0
  v_mov_b32 v104, 0
  v_mov_b32 v105, 0
  v_mov_b32 v106, 0
  v_mov_b32 v107, 0
  v_mov_b32 v108, 0
  v_mov_b32 v109, 0
  v_mov_b32 v110, 0
  v_mov_b32 v111, 0
  v_mov_b32 v112, 0
  v_mov_b32 v113, 0
  v_mov_b32 v114, 0
  v_mov_b32 v115, 0
  v_mov_b32 v116, 0
  v_mov_b32 v117, 0
  v_mov_b32 v118, 0
  v_mov_b32 v119, 0
  v_mov_b32 v120, 0
  v_mov_b32 v121, 0
  v_mov_b32 v122, 0
  v_mov_b32 v123, 0
  v_mov_b32 v124, 0
  v_mov_b32 v125, 0
  v_mov_b32 v126, 0
  v_mov_b32 v127, 0
  v_mov_b32 v88, 0
  v_mov_b32 v89, 0
  v_mov_b32 v90, 0
  v_mov_b32 v91, 0
  v_mov_b32 v92, 0
  v_mov_b32 v93, 0
  v_mov_b32 v94, 0
  v_mov_b32 v95, 0
  s_mul_i32 s34, s17, 20
  s_add_u32 s38, s34, 19
  s_lshr_b32 s34, s34, 7
  s_lshr_b32 s38, s38, 7
  s_sub_u32 s38, s38, s34
  v_bfe_u32 v45, v0, 4, 1
  v_mul_u32_u24 v45, s38, v45
  v_add_u32 v45, s34, v45
  v_and_b32 v44, 15, v0
  v_lshl_add_u32 v45, v45, 4, v44
  v_lshlrev_b32 v45, 7, v45
  v_mul_u32_u24 v44, 10240, v9
  v_add_u32 v44, v44, v45
  v_add_u32 v45, 20480, v45
  s_mov_b32 s38, 23822336
  v_mov_b32 v32, s54
  v_mov_b32 v33, 0
  s_waitcnt vmcnt(0)
  s_barrier
  s_cmp_lg_u32 s16, 0
  s_cbranch_scc1 PUB_73
  s_mov_b64 exec, 1
  buffer_store_dword v32, v33, s[12:15], s55 offen sc1
  s_mov_b64 exec, -1
PUB_73:
  s_cmp_lg_u32 s16, 0
  s_cbranch_scc1 POLL_74_Q
  s_mov_b32 s39, 0
POLL_74_P:
  s_add_u32 s39, s39, 1
  s_cmp_gt_u32 s39, 400000
  s_cbranch_scc1 POLL_74_X
  buffer_load_dword v32, v44, s[12:15], s38 offen sc1
  buffer_load_dword v33, v45, s[12:15], s38 offen sc1
  s_waitcnt vmcnt(0)
  v_cmp_ne_u32 vcc, s54, v33
  s_nop 1
  v_cndmask_b32 v32, v32, v33, vcc
  s_waitcnt vmcnt(0)
  v_cmp_ne_u32 vcc, s54, v32
  s_nop 4
  s_cbranch_vccnz POLL_74_P
POLL_74_X:
  s_mov_b64 exec, -1
POLL_74_Q:
  s_barrier
  buffer_load_dwordx4 v[20:23], v12, s[12:15], s4 offen offset:0 sc1
  buffer_load_dwordx2 v[28:29], v10, s[12:15], s5 offen offset:0 sc1
  buffer_load_dwordx4 v[24:27], v12, s[12:15], s4 offen offset:1024 sc1
  buffer_load_dwordx2 v[30:31], v10, s[12:15], s5 offen offset:256 sc1
  v_subrev_u32 v11, 1, v9
  s_waitcnt vmcnt(0)
  v_and_b32 v28, v28, v11
  v_and_b32 v29, v29, v11
  v_and_b32 v30, v30, v11
  v_and_b32 v31, v31, v11
  s_barrier
  ds_read_b128 v[128:131], v13
  ds_read_b64 v[136:137], v14
  v_add_u32 v13, s37, v13
  v_mad_i32_i24 v14, s37, v17, v14
  s_waitcnt lgkmcnt(0)
  v_mfma_f32_32x32x16_bf16 v[32:47], v[128:131], v[20:23], 0
  v_mfma_f32_32x32x8_bf16 v[32:47], v[136:137], v[28:29], v[32:47]
  v_mfma_f32_32x32x16_bf16 v[64:79], v[128:131], v[24:27], 0
  v_mfma_f32_32x32x8_bf16 v[64:79], v[136:137], v[30:31], v[64:79]
  ds_read_b128 v[128:131], v13
  ds_read_b128 v[132:135], v13 offset:1024
  ds_read_b64 v[136:137], v14
  ds_read_b64 v[138:139], v14 offset:256
  ds_read_b128 v[140:143], v15
  v_not_b32 v11, v11
  s_nop 7
  v_max3_f32 v48, v32, v33, v34
  v_max3_f32 v48, v48, v35, v36
  v_max3_f32 v48, v48, v37, v38
  v_max3_f32 v48, v48, v39, v40
  v_max3_f32 v48, v48, v41, v42
  v_max3_f32 v48, v48, v43, v44
  v_max3_f32 v48, v48, v45, v46
  v_max_f32 v48, v48, v47
  v_mov_b32 v49, v48
  s_nop 1
  v_permlane32_swap_b32 v48, v49
  v_max_f32 v48, v48, v49
  v_cvt_pk_bf16_f32 v48, -v48, 0
  v_and_or_b32 v28, v48, v11, v28
  v_max3_f32 v80, v64, v65, v66
  v_max3_f32 v80, v80, v67, v68
  v_max3_f32 v80, v80, v69, v70
  v_max3_f32 v80, v80, v71, v72
  v_max3_f32 v80, v80, v73, v74
  v_max3_f32 v80, v80, v75, v76
  v_max3_f32 v80, v80, v77, v78
  v_max_f32 v80, v80, v79
  v_mov_b32 v81, v80
  s_nop 1
  v_permlane32_swap_b32 v80, v81
  v_max_f32 v80, v80, v81
  v_cvt_pk_bf16_f32 v80, -v80, 0
  v_and_or_b32 v30, v80, v11, v30
  s_mov_b32 s53, 17920
  s_nop 0
  s_waitcnt lgkmcnt(0)
  v_mfma_f32_32x32x16_bf16 v[32:47], v[128:131], v[20:23], 0
  v_mfma_f32_32x32x8_bf16 v[32:47], v[136:137], v[28:29], v[32:47]
  v_mfma_f32_32x32x16_bf16 v[64:79], v[128:131], v[24:27], 0
  v_mfma_f32_32x32x8_bf16 v[64:79], v[136:137], v[30:31], v[64:79]
  s_mov_b32 s8, s20
  s_mov_b32 s9, s21
  s_mov_b32 s10, 2621440
  s_mov_b32 s11, 0x20000
  s_lshl_b32 s34, s40, 2
  s_add_u32 s34, s34, s6
  s_mul_i32 s34, s34, 20480
  s_mul_i32 s35, s41, 160
  s_add_u32 s34, s34, s35
  s_mul_i32 s35, s7, 96
  s_add_u32 s34, s34, s35
  v_and_b32 v10, 15, v0
  v_mul_u32_u24 v10, 1280, v10
  v_lshrrev_b32 v11, 4, v0
  v_lshl_add_u32 v10, v11, 3, v10
  buffer_load_dwordx2 v[2:3], v10, s[8:11], s34 offen offset:0
  buffer_load_dwordx2 v[4:5], v10, s[8:11], s34 offen offset:32
  buffer_load_dwordx2 v[6:7], v10, s[8:11], s34 offen offset:64
  s_mov_b32 s34, 0
  s_mov_b32 s35, 20480
  s_setprio 3
  s_nop 7
.p2align 6
KB_LOOP:
  s_setprio 2
  s_waitcnt lgkmcnt(0)
  ds_read_b128 v[148:151], v15 offset:640
  ds_read_b128 v[144:147], v15 offset:1280
  ds_read_b64 v[136:137], v14 offset:512
  ds_read_b128 v[128:131], v13 offset:2048
  v_smfmac_f32_32x32x32_bf16 v[112:127], v[152:155], v[88:95], v16
  v_exp_f32 v32, v32
  v_exp_f32 v33, v33
  v_exp_f32 v34, v34
  v_exp_f32 v35, v35
  v_mfma_f32_32x32x16_bf16 v[48:63], v[132:135], v[20:23], 0
  v_exp_f32 v36, v36
  v_exp_f32 v37, v37
  v_exp_f32 v38, v38
  v_exp_f32 v39, v39
  v_mfma_f32_32x32x8_bf16 v[48:63], v[138:139], v[28:29], v[48:63]
  v_exp_f32 v40, v40
  v_exp_f32 v41, v41
  v_exp_f32 v42, v42
  v_exp_f32 v43, v43
  v_smfmac_f32_32x32x32_bf16 v[96:111], v[140:143], v[32:39], v16
  v_exp_f32 v44, v44
  v_exp_f32 v45, v45
  v_exp_f32 v46, v46
  v_exp_f32_e64 v47, v47
  s_setprio 1
  s_waitcnt lgkmcnt(3)
  s_nop 0
  v_smfmac_f32_32x32x32_bf16 v[96:111], v[148:151], v[40:47], v16
  v_exp_f32 v64, v64
  v_exp_f32 v65, v65
  v_exp_f32 v66, v66
  v_exp_f32 v67, v67
  v_mfma_f32_32x32x16_bf16 v[80:95], v[132:135], v[24:27], 0
  v_exp_f32 v68, v68
  v_exp_f32 v69, v69
  v_exp_f32 v70, v70
  v_exp_f32 v71, v71
  v_mfma_f32_32x32x8_bf16 v[80:95], v[138:139], v[30:31], v[80:95]
  v_exp_f32 v72, v72
  v_exp_f32 v73, v73
  v_exp_f32 v74, v74
  v_exp_f32 v75, v75
  v_smfmac_f32_32x32x32_bf16 v[112:127], v[140:143], v[64:71], v16
  v_exp_f32 v76, v76
  v_exp_f32 v77, v77
  v_exp_f32 v78, v78
  v_exp_f32_e64 v79, v79
  s_waitcnt lgkmcnt(0)
  ds_read_b128 v[152:155], v15 offset:1920
  v_mad_i32_i24 v15, s52, v18, v15
  ds_read_b128 v[140:143], v15 offset:0
  ds_read_b64 v[138:139], v14 offset:768
  ds_read_b128 v[132:135], v13 offset:3072
  v_smfmac_f32_32x32x32_bf16 v[112:127], v[148:151], v[72:79], v16
  v_exp_f32 v48, v48
  v_exp_f32 v49, v49
  v_exp_f32 v50, v50
  v_exp_f32 v51, v51
  v_mfma_f32_32x32x16_bf16 v[32:47], v[128:131], v[20:23], 0
  v_exp_f32 v52, v52
  v_exp_f32 v53, v53
  v_exp_f32 v54, v54
  v_exp_f32 v55, v55
  v_mfma_f32_32x32x8_bf16 v[32:47], v[136:137], v[28:29], v[32:47]
  v_exp_f32 v56, v56
  v_exp_f32 v57, v57
  v_exp_f32 v58, v58
  v_exp_f32 v59, v59
  v_smfmac_f32_32x32x32_bf16 v[96:111], v[144:147], v[48:55], v16
  v_exp_f32 v60, v60
  v_exp_f32 v61, v61
  v_exp_f32 v62, v62
  v_exp_f32_e64 v63, v63
  s_setprio 0
  s_waitcnt lgkmcnt(3)
  s_nop 0
  v_smfmac_f32_32x32x32_bf16 v[96:111], v[152:155], v[56:63], v16
  v_exp_f32 v80, v80
  v_exp_f32 v81, v81
  v_exp_f32 v82, v82
  v_exp_f32 v83, v83
  v_mfma_f32_32x32x16_bf16 v[64:79], v[128:131], v[24:27], 0
  v_exp_f32 v84, v84
  v_exp_f32 v85, v85
  v_exp_f32 v86, v86
  v_exp_f32 v87, v87
  v_mfma_f32_32x32x8_bf16 v[64:79], v[136:137], v[30:31], v[64:79]
  v_exp_f32 v88, v88
  v_exp_f32 v89, v89
  v_exp_f32 v90, v90
  v_exp_f32 v91, v91
  v_smfmac_f32_32x32x32_bf16 v[112:127], v[144:147], v[80:87], v16
  v_exp_f32 v92, v92
  v_exp_f32 v93, v93
  v_exp_f32 v94, v94
  v_exp_f32 v95, v95
  s_setprio 3
  s_waitcnt lgkmcnt(0)
  s_barrier
  v_add_u32 v13, s35, v13
  v_mad_i32_i24 v14, s35, v17, v14
  ds_read_b128 v[148:151], v15 offset:640
  ds_read_b128 v[144:147], v15 offset:1280
  ds_read_b64 v[136:137], v14 offset:0
  ds_read_b128 v[128:131], v13 offset:0
  v_smfmac_f32_32x32x32_bf16 v[112:127], v[152:155], v[88:95], v16
  v_exp_f32 v32, v32
  v_exp_f32 v33, v33
  v_exp_f32 v34, v34
  v_exp_f32 v35, v35
  v_mfma_f32_32x32x16_bf16 v[48:63], v[132:135], v[20:23], 0
  v_exp_f32 v36, v36
  v_exp_f32 v37, v37
  v_exp_f32 v38, v38
  v_exp_f32 v39, v39
  v_mfma_f32_32x32x8_bf16 v[48:63], v[138:139], v[28:29], v[48:63]
  v_exp_f32 v40, v40
  v_exp_f32 v41, v41
  v_exp_f32 v42, v42
  v_exp_f32 v43, v43
  v_smfmac_f32_32x32x32_bf16 v[96:111], v[140:143], v[32:39], v16
  v_exp_f32 v44, v44
  v_exp_f32 v45, v45
  v_exp_f32 v46, v46
  v_exp_f32 v47, v47
  s_waitcnt lgkmcnt(3)
  s_nop 0
  v_smfmac_f32_32x32x32_bf16 v[96:111], v[148:151], v[40:47], v16
  v_exp_f32 v64, v64
  v_exp_f32 v65, v65
  v_exp_f32 v66, v66
  v_exp_f32 v67, v67
  v_mfma_f32_32x32x16_bf16 v[80:95], v[132:135], v[24:27], 0
  v_exp_f32 v68, v68
  v_exp_f32 v69, v69
  v_exp_f32 v70, v70
  v_exp_f32 v71, v71
  v_mfma_f32_32x32x8_bf16 v[80:95], v[138:139], v[30:31], v[80:95]
  v_exp_f32 v72, v72
  v_exp_f32 v73, v73
  v_exp_f32 v74, v74
  v_exp_f32 v75, v75
  v_smfmac_f32_32x32x32_bf16 v[112:127], v[140:143], v[64:71], v16
  v_exp_f32 v76, v76
  v_exp_f32 v77, v77
  v_exp_f32 v78, v78
  v_exp_f32_e64 v79, v79
  s_waitcnt lgkmcnt(0)
  ds_read_b128 v[152:155], v15 offset:1920
  v_mad_i32_i24 v15, s53, v18, v15
  ds_read_b128 v[140:143], v15 offset:0
  ds_read_b64 v[138:139], v14 offset:256
  ds_read_b128 v[132:135], v13 offset:1024
  v_smfmac_f32_32x32x32_bf16 v[112:127], v[148:151], v[72:79], v16
  v_exp_f32 v48, v48
  v_exp_f32 v49, v49
  v_exp_f32 v50, v50
  v_exp_f32 v51, v51
  v_mfma_f32_32x32x16_bf16 v[32:47], v[128:131], v[20:23], 0
  v_exp_f32 v52, v52
  v_exp_f32 v53, v53
  v_exp_f32 v54, v54
  v_exp_f32 v55, v55
  v_mfma_f32_32x32x8_bf16 v[32:47], v[136:137], v[28:29], v[32:47]
  v_exp_f32 v56, v56
  v_exp_f32 v57, v57
  v_exp_f32 v58, v58
  v_exp_f32 v59, v59
  v_smfmac_f32_32x32x32_bf16 v[96:111], v[144:147], v[48:55], v16
  v_exp_f32 v60, v60
  v_exp_f32 v61, v61
  v_exp_f32 v62, v62
  v_exp_f32_e64 v63, v63
  s_waitcnt lgkmcnt(3)
  s_add_u32 s34, s34, 1
  s_bitcmp1_b32 0x24, s34
  s_cselect_b32 s35, s50, s51
  s_sub_u32 s53, s35, s52
  v_smfmac_f32_32x32x32_bf16 v[96:111], v[152:155], v[56:63], v16
  v_exp_f32 v80, v80
  v_exp_f32 v81, v81
  v_exp_f32 v82, v82
  v_exp_f32 v83, v83
  v_mfma_f32_32x32x16_bf16 v[64:79], v[128:131], v[24:27], 0
  v_exp_f32 v84, v84
  v_exp_f32 v85, v85
  v_exp_f32 v86, v86
  v_exp_f32 v87, v87
  v_mfma_f32_32x32x8_bf16 v[64:79], v[136:137], v[30:31], v[64:79]
  v_exp_f32 v88, v88
  v_exp_f32 v89, v89
  v_exp_f32 v90, v90
  v_exp_f32 v91, v91
  v_smfmac_f32_32x32x32_bf16 v[112:127], v[144:147], v[80:87], v16
  v_exp_f32 v92, v92
  v_exp_f32 v93, v93
  v_exp_f32 v94, v94
  v_exp_f32 v95, v95
  s_cmp_lt_u32 s34, 8
  s_cbranch_scc1 KB_LOOP
  s_nop 0
  v_smfmac_f32_32x32x32_bf16 v[112:127], v[152:155], v[88:95], v16
  s_setprio 0
  s_movk_i32 s36, 5120
  s_cmp_lt_u32 s16, 5
  s_cselect_b32 s35, 0, s36
  s_mul_i32 s34, s16, 3072
  s_add_u32 s34, s34, s35
  s_add_u32 s34, s34, 81920
  v_add_u32 v13, s34, v12
  s_xor_b32 s34, s16, 4
  s_cmp_lt_u32 s34, 5
  s_cselect_b32 s35, 0, s36
  s_mul_i32 s34, s34, 3072
  s_add_u32 s34, s34, s35
  s_add_u32 s34, s34, 81920
  v_add_u32 v14, s34, v12
  s_add_u32 s33, s33, s32
  s_mul_i32 s35, s33, 40960
  s_add_u32 s35, s35, 9437184
  v_lshl_add_u32 v11, v8, 4, s35
  s_cmp_eq_u32 s32, 0
  s_cbranch_scc1 KB_X0
  ds_write_b128 v13, v[96:99] offset:0
  ds_write_b128 v13, v[100:103] offset:1024
  ds_write_b128 v13, v[104:107] offset:2048
  s_branch KB_X1
KB_X0:
  ds_write_b128 v13, v[112:115] offset:0
  ds_write_b128 v13, v[116:119] offset:1024
  ds_write_b128 v13, v[120:123] offset:2048
KB_X1:
  s_lshr_b32 s34, s17, 1
  s_mul_i32 s34, s34, 2560
  s_and_b32 s35, s17, 1
  s_mul_i32 s36, s35, 1536
  s_add_u32 s36, s36, s34
  v_lshl_add_u32 v32, v9, 9, v11
  v_add_u32 v32, s36, v32
  s_lshl_b32 s35, s35, 3
  s_add_u32 s34, s34, s35
  s_add_u32 s34, s34, 1024
  v_mul_u32_u24 v36, 8384512, v9
  v_lshl_add_u32 v34, v36, 8, v11
  v_add_u32 v34, s34, v34
  s_waitcnt lgkmcnt(0)
  s_barrier
  ds_read_b128 v[64:67], v14 offset:0
  ds_read_b128 v[68:71], v14 offset:1024
  ds_read_b128 v[72:75], v14 offset:2048
  s_cmp_eq_u32 s32, 0
  s_cbranch_scc1 KB_X2
  s_waitcnt lgkmcnt(2)
  v_pk_add_f32 v[96:97], v[112:113], v[64:65]
  v_pk_add_f32 v[98:99], v[114:115], v[66:67]
  s_waitcnt lgkmcnt(1)
  v_pk_add_f32 v[100:101], v[116:117], v[68:69]
  v_pk_add_f32 v[102:103], v[118:119], v[70:71]
  s_waitcnt lgkmcnt(0)
  v_pk_add_f32 v[104:105], v[120:121], v[72:73]
  v_pk_add_f32 v[106:107], v[122:123], v[74:75]
  s_branch KB_X3
KB_X2:
  s_waitcnt lgkmcnt(2)
  v_pk_add_f32 v[96:97], v[96:97], v[64:65]
  v_pk_add_f32 v[98:99], v[98:99], v[66:67]
  s_waitcnt lgkmcnt(1)
  v_pk_add_f32 v[100:101], v[100:101], v[68:69]
  v_pk_add_f32 v[102:103], v[102:103], v[70:71]
  s_waitcnt lgkmcnt(0)
  v_pk_add_f32 v[104:105], v[104:105], v[72:73]
  v_pk_add_f32 v[106:107], v[106:107], v[74:75]
KB_X3:
  v_mov_b32 v36, v104
  v_mov_b32 v37, v104
  s_mov_b64 s[38:39], 0
  s_nop 0
  v_permlane32_swap_b32 v36, v37
  v_rcp_f32 v36, v37
KB_OUT:
  s_nop 0
  v_pk_mul_f32 v[96:97], v[96:97], v[36:37] op_sel_hi:[1,0]
  v_pk_mul_f32 v[98:99], v[98:99], v[36:37] op_sel_hi:[1,0]
  v_pk_mul_f32 v[100:101], v[100:101], v[36:37] op_sel_hi:[1,0]
  v_pk_mul_f32 v[102:103], v[102:103], v[36:37] op_sel_hi:[1,0]
  v_pk_mul_f32 v[104:105], v[104:105], v[36:37] op_sel_hi:[1,0]
  v_pk_mul_f32 v[106:107], v[106:107], v[36:37] op_sel_hi:[1,0]
  v_cvt_pk_bf16_f32 v40, v96, v97
  v_cvt_pk_bf16_f32 v41, v98, v99
  v_cvt_pk_bf16_f32 v42, v100, v101
  v_cvt_pk_bf16_f32 v43, v102, v103
  v_cvt_pk_bf16_f32 v44, v104, v105
  v_cvt_pk_bf16_f32 v45, v106, v107
  buffer_store_dwordx2 v[44:45], v34, s[12:15], 0 offen sc1
  v_permlane32_swap_b32 v40, v42
  v_permlane32_swap_b32 v41, v43
  buffer_store_dwordx4 v[40:43], v32, s[12:15], 0 offen sc1
  v_fma_f32 v38, 0, v96, v37
  v_fma_f32 v38, 0, v97, v38
  v_fma_f32 v38, 0, v98, v38
  v_fma_f32 v38, 0, v99, v38
  v_fma_f32 v38, 0, v100, v38
  v_fma_f32 v38, 0, v101, v38
  v_fma_f32 v38, 0, v102, v38
  v_fma_f32 v38, 0, v103, v38
  v_fma_f32 v38, 0, v104, v38
  v_fma_f32 v38, 0, v105, v38
  v_fma_f32 v38, 0, v106, v38
  v_fma_f32 v38, 0, v107, v38
  v_cmp_gt_f32 vcc, 0x71800000, v38
  s_nop 4
  s_or_b64 vcc, vcc, s[38:39]
  s_cmp_eq_u64 vcc, -1
  s_cbranch_scc0 KB_SLOW
  s_lshl_b32 s34, s18, 5
  s_add_u32 s34, s34, s17
  s_lshl_b32 s34, s34, 7
  s_add_u32 s55, s34, 23724032
  s_lshl_b32 s35, s2, 2
  s_add_u32 s35, s35, 23859200
  v_mov_b32 v10, s54
  v_mov_b32 v11, 0
  s_waitcnt vmcnt(0)
  s_barrier
  s_cmp_lg_u32 s16, 0
  s_cbranch_scc1 PUB_75
  s_mov_b64 exec, 1
  buffer_store_dword v10, v11, s[12:15], s55 offen sc1
  buffer_store_dword v10, v11, s[12:15], s35 offen sc1
  s_mov_b64 exec, -1
PUB_75:
  v_and_b32 v8, 15, v0
  v_lshrrev_b32 v9, 4, v0
  s_lshr_b32 s34, s6, 1
  s_lshl_b32 s34, s34, 12
  s_and_b32 s36, s6, 1
  s_mul_i32 s35, s36, 2304
  s_add_u32 s34, s34, s35
  s_add_u32 s34, s34, 98304
  v_lshlrev_b32 v13, 9, v9
  v_lshl_add_u32 v13, v8, 4, v13
  v_add_u32 v13, s34, v13
  v_xor_b32 v14, 256, v13
  s_mul_i32 s34, s7, 3072
  s_mul_i32 s35, s36, 5120
  s_add_u32 s34, s34, s35
  v_lshl_add_u32 v15, v0, 4, s34
  v_add_u32 v16, 40960, v15
  v_lshlrev_b32 v20, 16, v2
  v_and_b32 v21, 0xffff0000, v2
  v_lshlrev_b32 v22, 16, v3
  v_and_b32 v23, 0xffff0000, v3
  v_lshlrev_b32 v24, 16, v4
  v_and_b32 v25, 0xffff0000, v4
  v_lshlrev_b32 v26, 16, v5
  v_and_b32 v27, 0xffff0000, v5
  v_lshlrev_b32 v28, 16, v6
  v_and_b32 v29, 0xffff0000, v6
  v_lshlrev_b32 v30, 16, v7
  v_and_b32 v31, 0xffff0000, v7
  v_mov_b32 v32, 0
  v_mov_b32 v33, 0
  v_mov_b32 v34, 0
  v_mov_b32 v35, 0
  v_mov_b32 v36, 0
  v_mov_b32 v37, 0
  v_mov_b32 v38, 0
  v_mov_b32 v39, 0
  v_mov_b32 v40, 0
  v_mov_b32 v41, 0
  v_mov_b32 v42, 0
  v_mov_b32 v43, 0
  s_lshr_b32 s37, s40, 2
  s_lshl_b32 s37, s37, 5
  s_add_u32 s37, s37, 185344
  s_lshl_b32 s37, s37, 7
  v_lshlrev_b32 v87, 7, v0
  s_cmp_lg_u32 s16, 0
  s_cbranch_scc1 POLL_76_Q
  s_mov_b32 exec_lo, 0xffffffff
  s_mov_b32 exec_hi, 0x0
  s_mov_b32 s39, 0
POLL_76_P:
  s_add_u32 s39, s39, 1
  s_cmp_gt_u32 s39, 400000
  s_cbranch_scc1 POLL_76_X
  buffer_load_dword v84, v87, s[12:15], s37 offen sc1
  s_waitcnt vmcnt(0)
  v_cmp_ne_u32 vcc, s54, v84
  s_nop 4
  s_cbranch_vccnz POLL_76_P
POLL_76_X:
  s_mov_b64 exec, -1
POLL_76_Q:
  s_barrier
  s_mov_b32 s38, 1
  s_mov_b32 s35, 99
  s_cmp_eq_u32 s7, 1
  s_cbranch_scc1 KR1_IN
KR0_IN:
  s_mov_b32 s39, 0
  s_barrier
  ds_read_b128 v[44:47], v13 offset:0
  ds_read_b128 v[48:51], v14 offset:0
  ds_read_b128 v[60:63], v15 offset:0
  ds_read_b128 v[64:67], v15 offset:1024
  ds_read_b128 v[68:71], v15 offset:2048
  s_branch KR0_1
.p2align 6
KR0_L:
  s_barrier
  ds_read_b128 v[44:47], v13 offset:0
  ds_read_b128 v[48:51], v14 offset:0
  ds_read_b128 v[60:63], v15 offset:0
  ds_read_b128 v[64:67], v15 offset:1024
  ds_read_b128 v[68:71], v15 offset:2048
  s_waitcnt lgkmcnt(5)
  v_mfma_f32_16x16x32_bf16 v[20:23], v[72:75], v[52:55], v[20:23]
  v_mfma_f32_16x16x32_bf16 v[32:35], v[72:75], v[56:59], v[32:35]
  v_mfma_f32_16x16x32_bf16 v[24:27], v[76:79], v[52:55], v[24:27]
  v_mfma_f32_16x16x32_bf16 v[36:39], v[76:79], v[56:59], v[36:39]
  v_mfma_f32_16x16x32_bf16 v[28:31], v[80:83], v[52:55], v[28:31]
  v_mfma_f32_16x16x32_bf16 v[40:43], v[80:83], v[56:59], v[40:43]
KR0_1:
  s_barrier
  ds_read_b128 v[52:55], v13 offset:8192
  ds_read_b128 v[56:59], v14 offset:8192
  ds_read_b128 v[72:75], v15 offset:10240
  ds_read_b128 v[76:79], v15 offset:11264
  ds_read_b128 v[80:83], v15 offset:12288
  s_waitcnt lgkmcnt(5)
  v_mfma_f32_16x16x32_bf16 v[20:23], v[60:63], v[44:47], v[20:23]
  v_mfma_f32_16x16x32_bf16 v[32:35], v[60:63], v[48:51], v[32:35]
  v_mfma_f32_16x16x32_bf16 v[24:27], v[64:67], v[44:47], v[24:27]
  v_mfma_f32_16x16x32_bf16 v[36:39], v[64:67], v[48:51], v[36:39]
  v_mfma_f32_16x16x32_bf16 v[28:31], v[68:71], v[44:47], v[28:31]
  v_mfma_f32_16x16x32_bf16 v[40:43], v[68:71], v[48:51], v[40:43]
  s_cmp_eq_u32 s39, s38
  s_cbranch_scc1 KR0_OE
  s_cmp_lg_u32 s39, s35
  s_cbranch_scc1 KR0_K
  buffer_load_dword v84, v87, s[12:15], s37 offen sc1
KR0_K:
  s_barrier
  ds_read_b128 v[44:47], v13 offset:16384
  ds_read_b128 v[48:51], v14 offset:16384
  ds_read_b128 v[60:63], v15 offset:20480
  ds_read_b128 v[64:67], v15 offset:21504
  ds_read_b128 v[68:71], v15 offset:22528
  s_waitcnt lgkmcnt(5)
  v_mfma_f32_16x16x32_bf16 v[20:23], v[72:75], v[52:55], v[20:23]
  v_mfma_f32_16x16x32_bf16 v[32:35], v[72:75], v[56:59], v[32:35]
  v_mfma_f32_16x16x32_bf16 v[24:27], v[76:79], v[52:55], v[24:27]
  v_mfma_f32_16x16x32_bf16 v[36:39], v[76:79], v[56:59], v[36:39]
  v_mfma_f32_16x16x32_bf16 v[28:31], v[80:83], v[52:55], v[28:31]
  v_mfma_f32_16x16x32_bf16 v[40:43], v[80:83], v[56:59], v[40:43]
  s_cmp_eq_u32 s39, 3
  s_cbranch_scc1 KR0_DE
  s_barrier
  ds_read_b128 v[52:55], v13 offset:24576
  ds_read_b128 v[56:59], v14 offset:24576
  ds_read_b128 v[72:75], v15 offset:30720
  ds_read_b128 v[76:79], v15 offset:31744
  ds_read_b128 v[80:83], v15 offset:32768
  s_waitcnt lgkmcnt(5)
  v_mfma_f32_16x16x32_bf16 v[20:23], v[60:63], v[44:47], v[20:23]
  v_mfma_f32_16x16x32_bf16 v[32:35], v[60:63], v[48:51], v[32:35]
  v_mfma_f32_16x16x32_bf16 v[24:27], v[64:67], v[44:47], v[24:27]
  v_mfma_f32_16x16x32_bf16 v[36:39], v[64:67], v[48:51], v[36:39]
  v_mfma_f32_16x16x32_bf16 v[28:31], v[68:71], v[44:47], v[28:31]
  v_mfma_f32_16x16x32_bf16 v[40:43], v[68:71], v[48:51], v[40:43]
  s_cmp_lg_u32 s39, s35
  s_cbranch_scc1 KR0_M
  s_mov_b32 s34, 0
  s_branch POLL_77_C
POLL_77_P:
  s_add_u32 s34, s34, 1
  s_cmp_gt_u32 s34, 400000
  s_cbranch_scc1 POLL_77_X
  buffer_load_dword v84, v87, s[12:15], s37 offen sc1
POLL_77_C:
  s_waitcnt vmcnt(0)
  v_cmp_ne_u32 vcc, s54, v84
  s_nop 4
  s_cbranch_vccnz POLL_77_P
POLL_77_X:
  s_mov_b64 exec, -1
POLL_77_Q:
KR0_M:
  s_waitcnt vmcnt(0)
  s_barrier
  ds_read_b128 v[44:47], v13 offset:32768
  ds_read_b128 v[48:51], v14 offset:32768
  ds_read_b128 v[60:63], v16 offset:0
  ds_read_b128 v[64:67], v16 offset:1024
  ds_read_b128 v[68:71], v16 offset:2048
  s_waitcnt lgkmcnt(5)
  v_mfma_f32_16x16x32_bf16 v[20:23], v[72:75], v[52:55], v[20:23]
  v_mfma_f32_16x16x32_bf16 v[32:35], v[72:75], v[56:59], v[32:35]
  v_mfma_f32_16x16x32_bf16 v[24:27], v[76:79], v[52:55], v[24:27]
  v_mfma_f32_16x16x32_bf16 v[36:39], v[76:79], v[56:59], v[36:39]
  v_mfma_f32_16x16x32_bf16 v[28:31], v[80:83], v[52:55], v[28:31]
  v_mfma_f32_16x16x32_bf16 v[40:43], v[80:83], v[56:59], v[40:43]
  s_barrier
  ds_read_b128 v[52:55], v13 offset:40960
  ds_read_b128 v[56:59], v14 offset:40960
  ds_read_b128 v[72:75], v16 offset:10240
  ds_read_b128 v[76:79], v16 offset:11264
  ds_read_b128 v[80:83], v16 offset:12288
  s_waitcnt lgkmcnt(5)
  v_mfma_f32_16x16x32_bf16 v[20:23], v[60:63], v[44:47], v[20:23]
  v_mfma_f32_16x16x32_bf16 v[32:35], v[60:63], v[48:51], v[32:35]
  v_mfma_f32_16x16x32_bf16 v[24:27], v[64:67], v[44:47], v[24:27]
  v_mfma_f32_16x16x32_bf16 v[36:39], v[64:67], v[48:51], v[36:39]
  v_mfma_f32_16x16x32_bf16 v[28:31], v[68:71], v[44:47], v[28:31]
  v_mfma_f32_16x16x32_bf16 v[40:43], v[68:71], v[48:51], v[40:43]
  s_barrier
  ds_read_b128 v[44:47], v13 offset:49152
  ds_read_b128 v[48:51], v14 offset:49152
  ds_read_b128 v[60:63], v16 offset:20480
  ds_read_b128 v[64:67], v16 offset:21504
  ds_read_b128 v[68:71], v16 offset:22528
  s_waitcnt lgkmcnt(5)
  v_mfma_f32_16x16x32_bf16 v[20:23], v[72:75], v[52:55], v[20:23]
  v_mfma_f32_16x16x32_bf16 v[32:35], v[72:75], v[56:59], v[32:35]
  v_mfma_f32_16x16x32_bf16 v[24:27], v[76:79], v[52:55], v[24:27]
  v_mfma_f32_16x16x32_bf16 v[36:39], v[76:79], v[56:59], v[36:39]
  v_mfma_f32_16x16x32_bf16 v[28:31], v[80:83], v[52:55], v[28:31]
  v_mfma_f32_16x16x32_bf16 v[40:43], v[80:83], v[56:59], v[40:43]
  s_barrier
  ds_read_b128 v[52:55], v13 offset:57344
  ds_read_b128 v[56:59], v14 offset:57344
  ds_read_b128 v[72:75], v16 offset:30720
  ds_read_b128 v[76:79], v16 offset:31744
  ds_read_b128 v[80:83], v16 offset:32768
  s_waitcnt lgkmcnt(5)
  v_mfma_f32_16x16x32_bf16 v[20:23], v[60:63], v[44:47], v[20:23]
  v_mfma_f32_16x16x32_bf16 v[32:35], v[60:63], v[48:51], v[32:35]
  v_mfma_f32_16x16x32_bf16 v[24:27], v[64:67], v[44:47], v[24:27]
  v_mfma_f32_16x16x32_bf16 v[36:39], v[64:67], v[48:51], v[36:39]
  v_mfma_f32_16x16x32_bf16 v[28:31], v[68:71], v[44:47], v[28:31]
  v_mfma_f32_16x16x32_bf16 v[40:43], v[68:71], v[48:51], v[40:43]
  s_add_u32 s39, s39, 1
  s_branch KR0_L
KR0_OE:
  s_waitcnt vmcnt(0) lgkmcnt(0)
  v_mfma_f32_16x16x32_bf16 v[20:23], v[72:75], v[52:55], v[20:23]
  v_mfma_f32_16x16x32_bf16 v[32:35], v[72:75], v[56:59], v[32:35]
  v_mfma_f32_16x16x32_bf16 v[24:27], v[76:79], v[52:55], v[24:27]
  v_mfma_f32_16x16x32_bf16 v[36:39], v[76:79], v[56:59], v[36:39]
  v_mfma_f32_16x16x32_bf16 v[28:31], v[80:83], v[52:55], v[28:31]
  v_mfma_f32_16x16x32_bf16 v[40:43], v[80:83], v[56:59], v[40:43]
  s_mul_i32 s34, s16, 3072
  s_add_u32 s34, s34, 40960
  v_lshl_add_u32 v10, v0, 4, s34
  s_xor_b32 s34, s16, 6
  s_mul_i32 s34, s34, 3072
  s_add_u32 s34, s34, 40960
  v_lshl_add_u32 v11, v0, 4, s34
  s_nop 0
  ds_write_b128 v10, v[32:35] offset:0
  ds_write_b128 v10, v[36:39] offset:1024
  ds_write_b128 v10, v[40:43] offset:2048
  s_waitcnt lgkmcnt(0)
  s_barrier
  ds_read_b128 v[60:63], v11 offset:0
  ds_read_b128 v[64:67], v11 offset:1024
  ds_read_b128 v[68:71], v11 offset:2048
  s_lshl_b32 s34, s40, 1
  s_lshr_b32 s35, s6, 1
  s_add_u32 s34, s34, s35
  s_mul_i32 s34, s34, 40960
  s_mul_i32 s35, s41, 5120
  s_add_u32 s34, s34, s35
  s_and_b32 s35, s6, 1
  s_lshl_b32 s35, s35, 8
  s_add_u32 s34, s34, s35
  s_mul_i32 s35, s7, 3072
  s_add_u32 s34, s34, s35
  s_add_u32 s34, s34, 12582912
  v_lshrrev_b32 v10, 1, v9
  v_lshlrev_b32 v10, 9, v10
  v_lshl_add_u32 v10, v8, 4, v10
  v_and_b32 v11, 1, v9
  v_lshl_add_u32 v12, v11, 3, v10
  s_waitcnt lgkmcnt(2)
  v_pk_add_f32 v[20:21], v[20:21], v[60:61]
  v_pk_add_f32 v[22:23], v[22:23], v[62:63]
  s_waitcnt lgkmcnt(1)
  v_pk_add_f32 v[24:25], v[24:25], v[64:65]
  v_pk_add_f32 v[26:27], v[26:27], v[66:67]
  s_waitcnt lgkmcnt(0)
  v_pk_add_f32 v[28:29], v[28:29], v[68:69]
  v_pk_add_f32 v[30:31], v[30:31], v[70:71]
  v_cvt_pk_bf16_f32 v2, v20, v21
  v_cvt_pk_bf16_f32 v3, v22, v23
  v_cvt_pk_bf16_f32 v4, v24, v25
  v_cvt_pk_bf16_f32 v5, v26, v27
  v_cvt_pk_bf16_f32 v6, v28, v29
  v_cvt_pk_bf16_f32 v7, v30, v31
  v_mov_b32 v44, v2
  v_mov_b32 v45, v3
  v_mov_b32 v46, v4
  v_mov_b32 v47, v5
  buffer_store_dwordx2 v[6:7], v12, s[12:15], s34 offen offset:2048 sc1
  v_lshl_add_u32 v10, v11, 10, v10
  s_nop 0
  v_permlane16_swap_b32 v44, v46
  v_permlane16_swap_b32 v45, v47
  buffer_store_dwordx4 v[44:47], v10, s[12:15], s34 offen sc1
  v_pk_add_f32 v[84:85], v[20:21], v[22:23]
  v_pk_mul_f32 v[86:87], v[20:21], v[20:21]
  v_pk_fma_f32 v[86:87], v[22:23], v[22:23], v[86:87]
  v_pk_add_f32 v[84:85], v[84:85], v[24:25]
  v_pk_fma_f32 v[86:87], v[24:25], v[24:25], v[86:87]
  v_pk_add_f32 v[84:85], v[84:85], v[26:27]
  v_pk_fma_f32 v[86:87], v[26:27], v[26:27], v[86:87]
  v_pk_add_f32 v[84:85], v[84:85], v[28:29]
  v_pk_fma_f32 v[86:87], v[28:29], v[28:29], v[86:87]
  v_pk_add_f32 v[84:85], v[84:85], v[30:31]
  v_pk_fma_f32 v[86:87], v[30:31], v[30:31], v[86:87]
  s_lshl_b32 s34, s40, 2
  s_add_u32 s34, s34, s6
  s_lshl_b32 s34, s34, 11
  s_lshl_b32 s35, s41, 1
  s_add_u32 s35, s35, s7
  s_lshl_b32 s35, s35, 7
  s_add_u32 s34, s34, s35
  s_add_u32 s34, s34, 23068672
  v_add_f32 v84, v84, v85
  v_add_f32 v85, v86, v87
  v_mov_b32 v86, v84
  v_mov_b32 v87, v85
  v_lshlrev_b32 v10, 3, v8
  s_nop 0
  v_permlane16_swap_b32 v84, v86
  v_permlane16_swap_b32 v85, v87
  v_pk_add_f32 v[84:85], v[84:85], v[86:87]
  v_mov_b32 v86, v84
  v_mov_b32 v87, v85
  s_nop 1
  v_permlane32_swap_b32 v84, v86
  v_permlane32_swap_b32 v85, v87
  v_pk_add_f32 v[84:85], v[84:85], v[86:87]
  s_mov_b64 exec, 0xffff
  buffer_store_dwordx2 v[84:85], v10, s[12:15], s34 offen sc1
  s_mov_b64 exec, -1
  s_branch KG_IN
KR0_DE:
  s_waitcnt vmcnt(0) lgkmcnt(0)
  v_mfma_f32_16x16x32_bf16 v[20:23], v[60:63], v[44:47], v[20:23]
  v_mfma_f32_16x16x32_bf16 v[32:35], v[60:63], v[48:51], v[32:35]
  v_mfma_f32_16x16x32_bf16 v[24:27], v[64:67], v[44:47], v[24:27]
  v_mfma_f32_16x16x32_bf16 v[36:39], v[64:67], v[48:51], v[36:39]
  v_mfma_f32_16x16x32_bf16 v[28:31], v[68:71], v[44:47], v[28:31]
  v_mfma_f32_16x16x32_bf16 v[40:43], v[68:71], v[48:51], v[40:43]
  s_mul_i32 s34, s16, 3072
  s_add_u32 s34, s34, 40960
  v_lshl_add_u32 v10, v0, 4, s34
  s_xor_b32 s34, s16, 6
  s_mul_i32 s34, s34, 3072
  s_add_u32 s34, s34, 40960
  v_lshl_add_u32 v11, v0, 4, s34
  s_nop 0
  ds_write_b128 v10, v[32:35] offset:0
  ds_write_b128 v10, v[36:39] offset:1024
  ds_write_b128 v10, v[40:43] offset:2048
  s_waitcnt lgkmcnt(0)
  s_barrier
  ds_read_b128 v[72:75], v11 offset:0
  ds_read_b128 v[76:79], v11 offset:1024
  ds_read_b128 v[80:83], v11 offset:2048
  s_mul_i32 s34, s6, 2816
  s_mul_i32 s35, s7, 96
  s_add_u32 s34, s34, s35
  s_add_u32 s34, s34, 71680
  v_mul_u32_u24 v10, 176, v8
  v_lshl_add_u32 v10, v9, 3, v10
  v_add_u32 v10, s34, v10
  s_waitcnt lgkmcnt(2)
  v_pk_add_f32 v[20:21], v[20:21], v[72:73]
  v_pk_add_f32 v[22:23], v[22:23], v[74:75]
  s_waitcnt lgkmcnt(1)
  v_pk_add_f32 v[24:25], v[24:25], v[76:77]
  v_pk_add_f32 v[26:27], v[26:27], v[78:79]
  s_waitcnt lgkmcnt(0)
  v_pk_add_f32 v[28:29], v[28:29], v[80:81]
  v_pk_add_f32 v[30:31], v[30:31], v[82:83]
  v_cvt_pk_bf16_f32 v84, v20, v21
  v_cvt_pk_bf16_f32 v85, v22, v23
  ds_write_b64 v10, v[84:85] offset:0
  v_cvt_pk_bf16_f32 v86, v24, v25
  v_cvt_pk_bf16_f32 v87, v26, v27
  ds_write_b64 v10, v[86:87] offset:32
  v_cvt_pk_bf16_f32 v88, v28, v29
  v_cvt_pk_bf16_f32 v89, v30, v31
  ds_write_b64 v10, v[88:89] offset:64
  s_branch K2_ST
KR1_IN:
  s_mov_b32 s39, 0
  s_barrier
  ds_read_b128 v[44:47], v13 offset:0
  ds_read_b128 v[48:51], v14 offset:0
  ds_read_b128 v[60:63], v15 offset:0
  ds_read_b128 v[64:67], v15 offset:1024
  s_branch KR1_1
.p2align 6
KR1_L:
  s_barrier
  ds_read_b128 v[44:47], v13 offset:0
  ds_read_b128 v[48:51], v14 offset:0
  ds_read_b128 v[60:63], v15 offset:0
  ds_read_b128 v[64:67], v15 offset:1024
  s_waitcnt lgkmcnt(4)
  v_mfma_f32_16x16x32_bf16 v[20:23], v[72:75], v[52:55], v[20:23]
  v_mfma_f32_16x16x32_bf16 v[32:35], v[72:75], v[56:59], v[32:35]
  v_mfma_f32_16x16x32_bf16 v[24:27], v[76:79], v[52:55], v[24:27]
  v_mfma_f32_16x16x32_bf16 v[36:39], v[76:79], v[56:59], v[36:39]
KR1_1:
  s_barrier
  ds_read_b128 v[52:55], v13 offset:8192
  ds_read_b128 v[56:59], v14 offset:8192
  ds_read_b128 v[72:75], v15 offset:10240
  ds_read_b128 v[76:79], v15 offset:11264
  s_waitcnt lgkmcnt(4)
  v_mfma_f32_16x16x32_bf16 v[20:23], v[60:63], v[44:47], v[20:23]
  v_mfma_f32_16x16x32_bf16 v[32:35], v[60:63], v[48:51], v[32:35]
  v_mfma_f32_16x16x32_bf16 v[24:27], v[64:67], v[44:47], v[24:27]
  v_mfma_f32_16x16x32_bf16 v[36:39], v[64:67], v[48:51], v[36:39]
  s_cmp_eq_u32 s39, s38
  s_cbranch_scc1 KR1_OE
  s_barrier
  ds_read_b128 v[44:47], v13 offset:16384
  ds_read_b128 v[48:51], v14 offset:16384
  ds_read_b128 v[60:63], v15 offset:20480
  ds_read_b128 v[64:67], v15 offset:21504
  s_waitcnt lgkmcnt(4)
  v_mfma_f32_16x16x32_bf16 v[20:23], v[72:75], v[52:55], v[20:23]
  v_mfma_f32_16x16x32_bf16 v[32:35], v[72:75], v[56:59], v[32:35]
  v_mfma_f32_16x16x32_bf16 v[24:27], v[76:79], v[52:55], v[24:27]
  v_mfma_f32_16x16x32_bf16 v[36:39], v[76:79], v[56:59], v[36:39]
  s_cmp_eq_u32 s39, 3
  s_cbranch_scc1 KR1_DE
  s_barrier
  ds_read_b128 v[52:55], v13 offset:24576
  ds_read_b128 v[56:59], v14 offset:24576
  ds_read_b128 v[72:75], v15 offset:30720
  ds_read_b128 v[76:79], v15 offset:31744
  s_waitcnt lgkmcnt(4)
  v_mfma_f32_16x16x32_bf16 v[20:23], v[60:63], v[44:47], v[20:23]
  v_mfma_f32_16x16x32_bf16 v[32:35], v[60:63], v[48:51], v[32:35]
  v_mfma_f32_16x16x32_bf16 v[24:27], v[64:67], v[44:47], v[24:27]
  v_mfma_f32_16x16x32_bf16 v[36:39], v[64:67], v[48:51], v[36:39]
  s_waitcnt vmcnt(0)
  s_barrier
  ds_read_b128 v[44:47], v13 offset:32768
  ds_read_b128 v[48:51], v14 offset:32768
  ds_read_b128 v[60:63], v16 offset:0
  ds_read_b128 v[64:67], v16 offset:1024
  s_waitcnt lgkmcnt(4)
  v_mfma_f32_16x16x32_bf16 v[20:23], v[72:75], v[52:55], v[20:23]
  v_mfma_f32_16x16x32_bf16 v[32:35], v[72:75], v[56:59], v[32:35]
  v_mfma_f32_16x16x32_bf16 v[24:27], v[76:79], v[52:55], v[24:27]
  v_mfma_f32_16x16x32_bf16 v[36:39], v[76:79], v[56:59], v[36:39]
  s_barrier
  ds_read_b128 v[52:55], v13 offset:40960
  ds_read_b128 v[56:59], v14 offset:40960
  ds_read_b128 v[72:75], v16 offset:10240
  ds_read_b128 v[76:79], v16 offset:11264
  s_waitcnt lgkmcnt(4)
  v_mfma_f32_16x16x32_bf16 v[20:23], v[60:63], v[44:47], v[20:23]
  v_mfma_f32_16x16x32_bf16 v[32:35], v[60:63], v[48:51], v[32:35]
  v_mfma_f32_16x16x32_bf16 v[24:27], v[64:67], v[44:47], v[24:27]
  v_mfma_f32_16x16x32_bf16 v[36:39], v[64:67], v[48:51], v[36:39]
  s_barrier
  ds_read_b128 v[44:47], v13 offset:49152
  ds_read_b128 v[48:51], v14 offset:49152
  ds_read_b128 v[60:63], v16 offset:20480
  ds_read_b128 v[64:67], v16 offset:21504
  s_waitcnt lgkmcnt(4)
  v_mfma_f32_16x16x32_bf16 v[20:23], v[72:75], v[52:55], v[20:23]
  v_mfma_f32_16x16x32_bf16 v[32:35], v[72:75], v[56:59], v[32:35]
  v_mfma_f32_16x16x32_bf16 v[24:27], v[76:79], v[52:55], v[24:27]
  v_mfma_f32_16x16x32_bf16 v[36:39], v[76:79], v[56:59], v[36:39]
  s_barrier
  ds_read_b128 v[52:55], v13 offset:57344
  ds_read_b128 v[56:59], v14 offset:57344
  ds_read_b128 v[72:75], v16 offset:30720
  ds_read_b128 v[76:79], v16 offset:31744
  s_waitcnt lgkmcnt(4)
  v_mfma_f32_16x16x32_bf16 v[20:23], v[60:63], v[44:47], v[20:23]
  v_mfma_f32_16x16x32_bf16 v[32:35], v[60:63], v[48:51], v[32:35]
  v_mfma_f32_16x16x32_bf16 v[24:27], v[64:67], v[44:47], v[24:27]
  v_mfma_f32_16x16x32_bf16 v[36:39], v[64:67], v[48:51], v[36:39]
  s_add_u32 s39, s39, 1
  s_branch KR1_L
KR1_OE:
  s_waitcnt vmcnt(0) lgkmcnt(0)
  v_mfma_f32_16x16x32_bf16 v[20:23], v[72:75], v[52:55], v[20:23]
  v_mfma_f32_16x16x32_bf16 v[32:35], v[72:75], v[56:59], v[32:35]
  v_mfma_f32_16x16x32_bf16 v[24:27], v[76:79], v[52:55], v[24:27]
  v_mfma_f32_16x16x32_bf16 v[36:39], v[76:79], v[56:59], v[36:39]
  s_mul_i32 s34, s16, 3072
  s_add_u32 s34, s34, 40960
  v_lshl_add_u32 v10, v0, 4, s34
  s_xor_b32 s34, s16, 6
  s_mul_i32 s34, s34, 3072
  s_add_u32 s34, s34, 40960
  v_lshl_add_u32 v11, v0, 4, s34
  s_nop 0
  ds_write_b128 v10, v[32:35] offset:0
  ds_write_b128 v10, v[36:39] offset:1024
  s_waitcnt lgkmcnt(0)
  s_barrier
  ds_read_b128 v[60:63], v11 offset:0
  ds_read_b128 v[64:67], v11 offset:1024
  s_lshl_b32 s34, s40, 1
  s_lshr_b32 s35, s6, 1
  s_add_u32 s34, s34, s35
  s_mul_i32 s34, s34, 40960
  s_mul_i32 s35, s41, 5120
  s_add_u32 s34, s34, s35
  s_and_b32 s35, s6, 1
  s_lshl_b32 s35, s35, 8
  s_add_u32 s34, s34, s35
  s_mul_i32 s35, s7, 3072
  s_add_u32 s34, s34, s35
  s_add_u32 s34, s34, 12582912
  v_lshrrev_b32 v10, 1, v9
  v_lshlrev_b32 v10, 9, v10
  v_lshl_add_u32 v10, v8, 4, v10
  v_and_b32 v11, 1, v9
  v_lshl_add_u32 v12, v11, 3, v10
  s_waitcnt lgkmcnt(1)
  v_pk_add_f32 v[20:21], v[20:21], v[60:61]
  v_pk_add_f32 v[22:23], v[22:23], v[62:63]
  s_waitcnt lgkmcnt(0)
  v_pk_add_f32 v[24:25], v[24:25], v[64:65]
  v_pk_add_f32 v[26:27], v[26:27], v[66:67]
  v_cvt_pk_bf16_f32 v2, v20, v21
  v_cvt_pk_bf16_f32 v3, v22, v23
  v_cvt_pk_bf16_f32 v4, v24, v25
  v_cvt_pk_bf16_f32 v5, v26, v27
  v_mov_b32 v44, v2
  v_mov_b32 v45, v3
  v_mov_b32 v46, v4
  v_mov_b32 v47, v5
  v_lshl_add_u32 v10, v11, 10, v10
  s_nop 0
  v_permlane16_swap_b32 v44, v46
  v_permlane16_swap_b32 v45, v47
  buffer_store_dwordx4 v[44:47], v10, s[12:15], s34 offen sc1
  v_pk_add_f32 v[84:85], v[20:21], v[22:23]
  v_pk_mul_f32 v[86:87], v[20:21], v[20:21]
  v_pk_fma_f32 v[86:87], v[22:23], v[22:23], v[86:87]
  v_pk_add_f32 v[84:85], v[84:85], v[24:25]
  v_pk_fma_f32 v[86:87], v[24:25], v[24:25], v[86:87]
  v_pk_add_f32 v[84:85], v[84:85], v[26:27]
  v_pk_fma_f32 v[86:87], v[26:27], v[26:27], v[86:87]
  s_lshl_b32 s34, s40, 2
  s_add_u32 s34, s34, s6
  s_lshl_b32 s34, s34, 11
  s_lshl_b32 s35, s41, 1
  s_add_u32 s35, s35, s7
  s_lshl_b32 s35, s35, 7
  s_add_u32 s34, s34, s35
  s_add_u32 s34, s34, 23068672
  v_add_f32 v84, v84, v85
  v_add_f32 v85, v86, v87
  v_mov_b32 v86, v84
  v_mov_b32 v87, v85
  v_lshlrev_b32 v10, 3, v8
  s_nop 0
  v_permlane16_swap_b32 v84, v86
  v_permlane16_swap_b32 v85, v87
  v_pk_add_f32 v[84:85], v[84:85], v[86:87]
  v_mov_b32 v86, v84
  v_mov_b32 v87, v85
  s_nop 1
  v_permlane32_swap_b32 v84, v86
  v_permlane32_swap_b32 v85, v87
  v_pk_add_f32 v[84:85], v[84:85], v[86:87]
  s_mov_b64 exec, 0xffff
  buffer_store_dwordx2 v[84:85], v10, s[12:15], s34 offen sc1
  s_mov_b64 exec, -1
  s_branch KG_IN
KR1_DE:
  s_waitcnt vmcnt(0) lgkmcnt(0)
  v_mfma_f32_16x16x32_bf16 v[20:23], v[60:63], v[44:47], v[20:23]
  v_mfma_f32_16x16x32_bf16 v[32:35], v[60:63], v[48:51], v[32:35]
  v_mfma_f32_16x16x32_bf16 v[24:27], v[64:67], v[44:47], v[24:27]
  v_mfma_f32_16x16x32_bf16 v[36:39], v[64:67], v[48:51], v[36:39]
  s_mul_i32 s34, s16, 3072
  s_add_u32 s34, s34, 40960
  v_lshl_add_u32 v10, v0, 4, s34
  s_xor_b32 s34, s16, 6
  s_mul_i32 s34, s34, 3072
  s_add_u32 s34, s34, 40960
  v_lshl_add_u32 v11, v0, 4, s34
  s_nop 0
  ds_write_b128 v10, v[32:35] offset:0
  ds_write_b128 v10, v[36:39] offset:1024
  s_waitcnt lgkmcnt(0)
  s_barrier
  ds_read_b128 v[72:75], v11 offset:0
  ds_read_b128 v[76:79], v11 offset:1024
  s_mul_i32 s34, s6, 2816
  s_mul_i32 s35, s7, 96
  s_add_u32 s34, s34, s35
  s_add_u32 s34, s34, 71680
  v_mul_u32_u24 v10, 176, v8
  v_lshl_add_u32 v10, v9, 3, v10
  v_add_u32 v10, s34, v10
  s_waitcnt lgkmcnt(1)
  v_pk_add_f32 v[20:21], v[20:21], v[72:73]
  v_pk_add_f32 v[22:23], v[22:23], v[74:75]
  s_waitcnt lgkmcnt(0)
  v_pk_add_f32 v[24:25], v[24:25], v[76:77]
  v_pk_add_f32 v[26:27], v[26:27], v[78:79]
  v_cvt_pk_bf16_f32 v84, v20, v21
  v_cvt_pk_bf16_f32 v85, v22, v23
  ds_write_b64 v10, v[84:85] offset:0
  v_cvt_pk_bf16_f32 v86, v24, v25
  v_cvt_pk_bf16_f32 v87, v26, v27
  ds_write_b64 v10, v[86:87] offset:32
K2_ST:
  s_mov_b32 s8, s46
  s_mov_b32 s9, s47
  s_mov_b32 s10, 2621440
  s_mov_b32 s11, 0x20000
  s_mul_i32 s34, s16, 80
  s_mul_i32 s35, s40, 81920
  s_mul_i32 s36, s41, 160
  s_add_u32 s35, s35, s36
  v_add_u32 v10, s34, v0
  v_add_u32 v10, 0, v10
  v_mul_u32_u24 v11, 6554, v10
  v_lshrrev_b32 v11, 16, v11
  v_mad_i32_i24 v10, v11, -10, v10
  v_lshlrev_b32 v10, 4, v10
  v_mul_u32_u24 v52, 1280, v11
  v_add_u32 v52, v52, v10
  v_mul_u32_u24 v11, 176, v11
  v_add_u32 v54, v10, v11
  v_add_u32 v54, 71680, v54
  v_add_u32 v10, s34, v0
  v_add_u32 v10, 64, v10
  v_mul_u32_u24 v11, 6554, v10
  v_lshrrev_b32 v11, 16, v11
  v_mad_i32_i24 v10, v11, -10, v10
  v_lshlrev_b32 v10, 4, v10
  v_mul_u32_u24 v53, 1280, v11
  v_add_u32 v53, v53, v10
  v_mul_u32_u24 v11, 176, v11
  v_add_u32 v55, v10, v11
  v_add_u32 v55, 71680, v55
  s_waitcnt lgkmcnt(0)
  s_barrier
  ds_read_b128 v[44:47], v54
  ds_read_b128 v[48:51], v55
  s_waitcnt lgkmcnt(1)
  buffer_store_dwordx4 v[44:47], v52, s[8:11], s35 offen
  s_mov_b64 exec, 0xffff
  s_waitcnt lgkmcnt(0)
  buffer_store_dwordx4 v[48:51], v53, s[8:11], s35 offen
  s_endpgm
KG_IN:
  s_lshl_b32 s34, s40, 3
  s_add_u32 s34, s34, s41
  s_lshl_b32 s34, s34, 7
  s_add_u32 s55, s34, 23756800
  v_mov_b32 v10, s54
  v_mov_b32 v11, 0
  s_waitcnt vmcnt(0)
  s_barrier
  s_cmp_lg_u32 s16, 0
  s_cbranch_scc1 PUB_78
  s_mov_b64 exec, 1
  buffer_store_dword v10, v11, s[12:15], s55 offen sc1
  s_mov_b64 exec, -1
PUB_78:
  v_and_b32 v8, 15, v0
  v_lshrrev_b32 v9, 4, v0
  v_lshlrev_b32 v12, 4, v0
  s_lshl_b32 s34, s19, 11
  v_lshlrev_b32 v14, 9, v9
  v_lshl_add_u32 v14, v8, 4, v14
  v_add_u32 v14, s34, v14
  s_lshl_b32 s34, s32, 12
  s_add_u32 s34, s34, 8192
  v_add_u32 v16, s34, v12
  v_add_u32 v15, 98304, v14
  v_add_u32 v17, 98304, v16
  v_mov_b32 v36, 0
  v_mov_b32 v37, 0
  v_mov_b32 v38, 0
  v_mov_b32 v39, 0
  v_mov_b32 v40, 0
  v_mov_b32 v41, 0
  v_mov_b32 v42, 0
  v_mov_b32 v43, 0
  v_mov_b32 v44, 0
  v_mov_b32 v45, 0
  v_mov_b32 v46, 0
  v_mov_b32 v47, 0
  v_mov_b32 v48, 0
  v_mov_b32 v49, 0
  v_mov_b32 v50, 0
  v_mov_b32 v51, 0
  v_mov_b32 v52, 0
  v_mov_b32 v53, 0
  v_mov_b32 v54, 0
  v_mov_b32 v55, 0
  v_mov_b32 v56, 0
  v_mov_b32 v57, 0
  v_mov_b32 v58, 0
  v_mov_b32 v59, 0
  v_mov_b32 v60, 0
  v_mov_b32 v61, 0
  v_mov_b32 v62, 0
  v_mov_b32 v63, 0
  v_mov_b32 v64, 0
  v_mov_b32 v65, 0
  v_mov_b32 v66, 0
  v_mov_b32 v67, 0
  v_lshlrev_b32 v10, 3, v8
  v_lshl_add_u32 v10, v9, 9, v10
  s_lshl_b32 s36, s43, 2
  s_add_u32 s36, s36, s19
  s_lshl_b32 s35, s36, 1
  s_add_u32 s35, s35, s32
  s_lshl_b32 s35, s35, 11
  s_add_u32 s35, s35, 23068672
  s_lshl_b32 s34, s19, 9
  s_add_u32 s34, s34, 86016
  v_lshl_add_u32 v11, v8, 4, s34
  s_lshl_b32 s34, s32, 8
  v_add_u32 v13, s34, v11
  s_mul_i32 s36, s36, 110592
  s_lshl_b32 s34, s32, 11
  s_add_u32 s36, s36, s34
  s_add_u32 s36, s36, 15728640
  s_lshl_b32 s33, s3, 12
  s_add_u32 s33, s33, s36
  s_lshl_b32 s37, s43, 4
  s_add_u32 s37, s37, 185600
  s_lshl_b32 s37, s37, 7
  v_lshlrev_b32 v23, 7, v0
  s_cmp_lg_u32 s16, 0
  s_cbranch_scc1 POLL_79_Q
  s_mov_b32 exec_lo, 0xffff
  s_mov_b32 exec_hi, 0x0
  s_mov_b32 s39, 0
POLL_79_P:
  s_add_u32 s39, s39, 1
  s_cmp_gt_u32 s39, 400000
  s_cbranch_scc1 POLL_79_X
  buffer_load_dword v20, v23, s[12:15], s37 offen sc1
  s_waitcnt vmcnt(0)
  v_cmp_ne_u32 vcc, s54, v20
  s_nop 4
  s_cbranch_vccnz POLL_79_P
POLL_79_X:
  s_mov_b64 exec, -1
POLL_79_Q:
  s_barrier
  buffer_load_dwordx2 v[20:21], v10, s[12:15], s35 offen offset:0 sc1
  buffer_load_dwordx2 v[22:23], v10, s[12:15], s35 offen offset:128 sc1
  buffer_load_dwordx2 v[28:29], v10, s[12:15], s35 offen offset:256 sc1
  buffer_load_dwordx2 v[30:31], v10, s[12:15], s35 offen offset:384 sc1
  s_mov_b32 s39, 0
  s_barrier
  ds_read_b128 v[68:71], v14 offset:0
  ds_read_b128 v[72:75], v14 offset:256
  ds_read_b128 v[100:103], v16 offset:0
  ds_read_b128 v[104:107], v16 offset:1024
  ds_read_b128 v[108:111], v16 offset:2048
  ds_read_b128 v[112:115], v16 offset:3072
  ds_read_b128 v[76:79], v14 offset:16384
  ds_read_b128 v[80:83], v14 offset:16640
  ds_read_b128 v[116:119], v16 offset:16384
  ds_read_b128 v[120:123], v16 offset:17408
  ds_read_b128 v[124:127], v16 offset:18432
  ds_read_b128 v[128:131], v16 offset:19456
  s_waitcnt vmcnt(0)
  v_pk_add_f32 v[28:29], v[28:29], v[30:31]
  v_pk_add_f32 v[20:21], v[20:21], v[22:23]
  v_pk_add_f32 v[20:21], v[20:21], v[28:29]
  v_mov_b32 v22, v20
  v_mov_b32 v23, v21
  s_nop 1
  v_permlane16_swap_b32 v20, v22
  v_permlane16_swap_b32 v21, v23
  v_pk_add_f32 v[20:21], v[20:21], v[22:23]
  v_mov_b32 v22, v20
  v_mov_b32 v23, v21
  s_nop 1
  v_permlane32_swap_b32 v20, v22
  v_permlane32_swap_b32 v21, v23
  v_pk_add_f32 v[20:21], v[20:21], v[22:23]
  v_mul_f32 v20, 0xbacccccd, v20
  v_mul_f32 v21, 0x3acccccd, v21
  v_fma_f32 v22, -v20, v20, v21
  v_max_f32 v22, 0, v22
  v_add_f32 v22, 0x3727c5ac, v22
  v_rsq_f32 v21, v22
  s_nop 0
  v_mul_f32 v21, 0xbfb8aa3b, v21
  ds_write_b128 v13, v[20:23]
  s_lshl_b32 s34, s32, 7
  s_add_u32 s34, s34, 81920
  v_lshl_add_u32 v10, v9, 4, s34
  s_branch KG2_1
.p2align 6
KG2_L:
  s_waitcnt vmcnt(0) lgkmcnt(0)
  s_barrier
  v_mfma_f32_16x16x32_bf16 v[36:39], v[132:135], v[84:87], v[36:39]
  ds_read_b128 v[68:71], v14 offset:0
  v_mfma_f32_16x16x32_bf16 v[52:55], v[132:135], v[88:91], v[52:55]
  ds_read_b128 v[72:75], v14 offset:256
  v_mfma_f32_16x16x32_bf16 v[40:43], v[136:139], v[84:87], v[40:43]
  ds_read_b128 v[100:103], v16 offset:0
  v_mfma_f32_16x16x32_bf16 v[56:59], v[136:139], v[88:91], v[56:59]
  ds_read_b128 v[104:107], v16 offset:1024
  v_mfma_f32_16x16x32_bf16 v[44:47], v[140:143], v[84:87], v[44:47]
  ds_read_b128 v[108:111], v16 offset:2048
  v_mfma_f32_16x16x32_bf16 v[60:63], v[140:143], v[88:91], v[60:63]
  ds_read_b128 v[112:115], v16 offset:3072
  v_mfma_f32_16x16x32_bf16 v[48:51], v[144:147], v[84:87], v[48:51]
  ds_read_b128 v[76:79], v14 offset:16384
  v_mfma_f32_16x16x32_bf16 v[64:67], v[144:147], v[88:91], v[64:67]
  ds_read_b128 v[80:83], v14 offset:16640
  v_mfma_f32_16x16x32_bf16 v[36:39], v[148:151], v[92:95], v[36:39]
  ds_read_b128 v[116:119], v16 offset:16384
  v_mfma_f32_16x16x32_bf16 v[52:55], v[148:151], v[96:99], v[52:55]
  ds_read_b128 v[120:123], v16 offset:17408
  v_mfma_f32_16x16x32_bf16 v[40:43], v[152:155], v[92:95], v[40:43]
  ds_read_b128 v[124:127], v16 offset:18432
  v_mfma_f32_16x16x32_bf16 v[56:59], v[152:155], v[96:99], v[56:59]
  ds_read_b128 v[128:131], v16 offset:19456
  v_mfma_f32_16x16x32_bf16 v[44:47], v[156:159], v[92:95], v[44:47]
  v_mfma_f32_16x16x32_bf16 v[60:63], v[156:159], v[96:99], v[60:63]
  v_mfma_f32_16x16x32_bf16 v[48:51], v[160:163], v[92:95], v[48:51]
  v_mfma_f32_16x16x32_bf16 v[64:67], v[160:163], v[96:99], v[64:67]
KG2_1:
  s_waitcnt lgkmcnt(0)
  s_barrier
  v_mfma_f32_16x16x32_bf16 v[36:39], v[100:103], v[68:71], v[36:39]
  ds_read_b128 v[84:87], v14 offset:32768
  v_mfma_f32_16x16x32_bf16 v[52:55], v[100:103], v[72:75], v[52:55]
  ds_read_b128 v[88:91], v14 offset:33024
  v_mfma_f32_16x16x32_bf16 v[40:43], v[104:107], v[68:71], v[40:43]
  ds_read_b128 v[132:135], v16 offset:32768
  v_mfma_f32_16x16x32_bf16 v[56:59], v[104:107], v[72:75], v[56:59]
  ds_read_b128 v[136:139], v16 offset:33792
  v_mfma_f32_16x16x32_bf16 v[44:47], v[108:111], v[68:71], v[44:47]
  ds_read_b128 v[140:143], v16 offset:34816
  v_mfma_f32_16x16x32_bf16 v[60:63], v[108:111], v[72:75], v[60:63]
  ds_read_b128 v[144:147], v16 offset:35840
  v_mfma_f32_16x16x32_bf16 v[48:51], v[112:115], v[68:71], v[48:51]
  ds_read_b128 v[92:95], v14 offset:49152
  v_mfma_f32_16x16x32_bf16 v[64:67], v[112:115], v[72:75], v[64:67]
  ds_read_b128 v[96:99], v14 offset:49408
  v_mfma_f32_16x16x32_bf16 v[36:39], v[116:119], v[76:79], v[36:39]
  ds_read_b128 v[148:151], v16 offset:49152
  v_mfma_f32_16x16x32_bf16 v[52:55], v[116:119], v[80:83], v[52:55]
  ds_read_b128 v[152:155], v16 offset:50176
  v_mfma_f32_16x16x32_bf16 v[40:43], v[120:123], v[76:79], v[40:43]
  ds_read_b128 v[156:159], v16 offset:51200
  v_mfma_f32_16x16x32_bf16 v[56:59], v[120:123], v[80:83], v[56:59]
  ds_read_b128 v[160:163], v16 offset:52224
  v_mfma_f32_16x16x32_bf16 v[44:47], v[124:127], v[76:79], v[44:47]
  v_mfma_f32_16x16x32_bf16 v[60:63], v[124:127], v[80:83], v[60:63]
  v_mfma_f32_16x16x32_bf16 v[48:51], v[128:131], v[76:79], v[48:51]
  v_mfma_f32_16x16x32_bf16 v[64:67], v[128:131], v[80:83], v[64:67]
  s_cmp_eq_u32 s39, 2
  s_cbranch_scc1 KG2_E
  s_waitcnt lgkmcnt(0)
  s_barrier
  v_mfma_f32_16x16x32_bf16 v[36:39], v[132:135], v[84:87], v[36:39]
  ds_read_b128 v[68:71], v15 offset:0
  v_mfma_f32_16x16x32_bf16 v[52:55], v[132:135], v[88:91], v[52:55]
  ds_read_b128 v[72:75], v15 offset:256
  v_mfma_f32_16x16x32_bf16 v[40:43], v[136:139], v[84:87], v[40:43]
  ds_read_b128 v[100:103], v17 offset:0
  v_mfma_f32_16x16x32_bf16 v[56:59], v[136:139], v[88:91], v[56:59]
  ds_read_b128 v[104:107], v17 offset:1024
  v_mfma_f32_16x16x32_bf16 v[44:47], v[140:143], v[84:87], v[44:47]
  ds_read_b128 v[108:111], v17 offset:2048
  v_mfma_f32_16x16x32_bf16 v[60:63], v[140:143], v[88:91], v[60:63]
  ds_read_b128 v[112:115], v17 offset:3072
  v_mfma_f32_16x16x32_bf16 v[48:51], v[144:147], v[84:87], v[48:51]
  ds_read_b128 v[76:79], v15 offset:16384
  v_mfma_f32_16x16x32_bf16 v[64:67], v[144:147], v[88:91], v[64:67]
  ds_read_b128 v[80:83], v15 offset:16640
  v_mfma_f32_16x16x32_bf16 v[36:39], v[148:151], v[92:95], v[36:39]
  ds_read_b128 v[116:119], v17 offset:16384
  v_mfma_f32_16x16x32_bf16 v[52:55], v[148:151], v[96:99], v[52:55]
  ds_read_b128 v[120:123], v17 offset:17408
  v_mfma_f32_16x16x32_bf16 v[40:43], v[152:155], v[92:95], v[40:43]
  ds_read_b128 v[124:127], v17 offset:18432
  v_mfma_f32_16x16x32_bf16 v[56:59], v[152:155], v[96:99], v[56:59]
  ds_read_b128 v[128:131], v17 offset:19456
  v_mfma_f32_16x16x32_bf16 v[44:47], v[156:159], v[92:95], v[44:47]
  v_mfma_f32_16x16x32_bf16 v[60:63], v[156:159], v[96:99], v[60:63]
  v_mfma_f32_16x16x32_bf16 v[48:51], v[160:163], v[92:95], v[48:51]
  v_mfma_f32_16x16x32_bf16 v[64:67], v[160:163], v[96:99], v[64:67]
KG2_3:
  s_waitcnt lgkmcnt(0)
  s_barrier
  v_mfma_f32_16x16x32_bf16 v[36:39], v[100:103], v[68:71], v[36:39]
  ds_read_b128 v[84:87], v15 offset:32768
  v_mfma_f32_16x16x32_bf16 v[52:55], v[100:103], v[72:75], v[52:55]
  ds_read_b128 v[88:91], v15 offset:33024
  v_mfma_f32_16x16x32_bf16 v[40:43], v[104:107], v[68:71], v[40:43]
  ds_read_b128 v[132:135], v17 offset:32768
  v_mfma_f32_16x16x32_bf16 v[56:59], v[104:107], v[72:75], v[56:59]
  ds_read_b128 v[136:139], v17 offset:33792
  v_mfma_f32_16x16x32_bf16 v[44:47], v[108:111], v[68:71], v[44:47]
  ds_read_b128 v[140:143], v17 offset:34816
  v_mfma_f32_16x16x32_bf16 v[60:63], v[108:111], v[72:75], v[60:63]
  ds_read_b128 v[144:147], v17 offset:35840
  v_mfma_f32_16x16x32_bf16 v[48:51], v[112:115], v[68:71], v[48:51]
  ds_read_b128 v[92:95], v15 offset:49152
  v_mfma_f32_16x16x32_bf16 v[64:67], v[112:115], v[72:75], v[64:67]
  ds_read_b128 v[96:99], v15 offset:49408
  v_mfma_f32_16x16x32_bf16 v[36:39], v[116:119], v[76:79], v[36:39]
  ds_read_b128 v[148:151], v17 offset:49152
  v_mfma_f32_16x16x32_bf16 v[52:55], v[116:119], v[80:83], v[52:55]
  ds_read_b128 v[152:155], v17 offset:50176
  v_mfma_f32_16x16x32_bf16 v[40:43], v[120:123], v[76:79], v[40:43]
  ds_read_b128 v[156:159], v17 offset:51200
  v_mfma_f32_16x16x32_bf16 v[56:59], v[120:123], v[80:83], v[56:59]
  ds_read_b128 v[160:163], v17 offset:52224
  v_mfma_f32_16x16x32_bf16 v[44:47], v[124:127], v[76:79], v[44:47]
  v_mfma_f32_16x16x32_bf16 v[60:63], v[124:127], v[80:83], v[60:63]
  v_mfma_f32_16x16x32_bf16 v[48:51], v[128:131], v[76:79], v[48:51]
  v_mfma_f32_16x16x32_bf16 v[64:67], v[128:131], v[80:83], v[64:67]
  s_add_u32 s39, s39, 1
  s_cmp_lg_u32 s39, 5
  s_cbranch_scc1 KG2_L
KG2_E:
  s_waitcnt lgkmcnt(0)
  v_mfma_f32_16x16x32_bf16 v[36:39], v[132:135], v[84:87], v[36:39]
  ds_read_b128 v[20:23], v11 offset:0
  ds_read_b128 v[24:27], v11 offset:256
  ds_read_b128 v[100:103], v10 offset:0
  ds_read_b128 v[104:107], v10 offset:1024
  ds_read_b128 v[108:111], v10 offset:64
  ds_read_b128 v[112:115], v10 offset:1088
  v_mfma_f32_16x16x32_bf16 v[52:55], v[132:135], v[88:91], v[52:55]
  v_mfma_f32_16x16x32_bf16 v[40:43], v[136:139], v[84:87], v[40:43]
  v_mfma_f32_16x16x32_bf16 v[56:59], v[136:139], v[88:91], v[56:59]
  v_mfma_f32_16x16x32_bf16 v[44:47], v[140:143], v[84:87], v[44:47]
  v_mfma_f32_16x16x32_bf16 v[60:63], v[140:143], v[88:91], v[60:63]
  v_mfma_f32_16x16x32_bf16 v[48:51], v[144:147], v[84:87], v[48:51]
  v_mfma_f32_16x16x32_bf16 v[64:67], v[144:147], v[88:91], v[64:67]
  v_mfma_f32_16x16x32_bf16 v[36:39], v[148:151], v[92:95], v[36:39]
  v_mfma_f32_16x16x32_bf16 v[52:55], v[148:151], v[96:99], v[52:55]
  v_mfma_f32_16x16x32_bf16 v[40:43], v[152:155], v[92:95], v[40:43]
  v_mfma_f32_16x16x32_bf16 v[56:59], v[152:155], v[96:99], v[56:59]
  v_mfma_f32_16x16x32_bf16 v[44:47], v[156:159], v[92:95], v[44:47]
  v_mfma_f32_16x16x32_bf16 v[60:63], v[156:159], v[96:99], v[60:63]
  v_mfma_f32_16x16x32_bf16 v[48:51], v[160:163], v[92:95], v[48:51]
  v_mfma_f32_16x16x32_bf16 v[64:67], v[160:163], v[96:99], v[64:67]
  s_waitcnt lgkmcnt(0)
  v_mov_b32 v68, v21
  v_mov_b32 v70, v25
  s_nop 4
  v_pk_fma_f32 v[36:37], v[100:101], v[20:21], v[36:37] op_sel_hi:[1,0,1]
  v_pk_fma_f32 v[38:39], v[102:103], v[20:21], v[38:39] op_sel_hi:[1,0,1]
  v_pk_fma_f32 v[40:41], v[104:105], v[20:21], v[40:41] op_sel_hi:[1,0,1]
  v_pk_fma_f32 v[42:43], v[106:107], v[20:21], v[42:43] op_sel_hi:[1,0,1]
  v_pk_mul_f32 v[116:117], v[36:37], v[68:69] op_sel_hi:[1,0]
  v_pk_mul_f32 v[118:119], v[38:39], v[68:69] op_sel_hi:[1,0]
  v_exp_f32 v116, v116
  v_exp_f32 v117, v117
  v_exp_f32 v118, v118
  v_exp_f32 v119, v119
  v_pk_mul_f32 v[120:121], v[36:37], v[40:41]
  v_pk_mul_f32 v[122:123], v[38:39], v[42:43]
  v_pk_fma_f32 v[116:117], v[116:117], v[22:23], v[22:23] op_sel_hi:[1,0,0]
  v_pk_fma_f32 v[118:119], v[118:119], v[22:23], v[22:23] op_sel_hi:[1,0,0]
  v_rcp_f32 v116, v116
  v_rcp_f32 v117, v117
  v_rcp_f32 v118, v118
  v_rcp_f32 v119, v119
  s_nop 0
  v_pk_mul_f32 v[116:117], v[116:117], v[120:121]
  v_pk_mul_f32 v[118:119], v[118:119], v[122:123]
  v_cvt_pk_bf16_f32 v28, v116, v117
  v_cvt_pk_bf16_f32 v29, v118, v119
  v_pk_fma_f32 v[52:53], v[100:101], v[24:25], v[52:53] op_sel_hi:[1,0,1]
  v_pk_fma_f32 v[54:55], v[102:103], v[24:25], v[54:55] op_sel_hi:[1,0,1]
  v_pk_fma_f32 v[56:57], v[104:105], v[24:25], v[56:57] op_sel_hi:[1,0,1]
  v_pk_fma_f32 v[58:59], v[106:107], v[24:25], v[58:59] op_sel_hi:[1,0,1]
  v_pk_mul_f32 v[124:125], v[52:53], v[70:71] op_sel_hi:[1,0]
  v_pk_mul_f32 v[126:127], v[54:55], v[70:71] op_sel_hi:[1,0]
  v_exp_f32 v124, v124
  v_exp_f32 v125, v125
  v_exp_f32 v126, v126
  v_exp_f32 v127, v127
  v_pk_mul_f32 v[128:129], v[52:53], v[56:57]
  v_pk_mul_f32 v[130:131], v[54:55], v[58:59]
  v_pk_fma_f32 v[124:125], v[124:125], v[26:27], v[26:27] op_sel_hi:[1,0,0]
  v_pk_fma_f32 v[126:127], v[126:127], v[26:27], v[26:27] op_sel_hi:[1,0,0]
  v_rcp_f32 v124, v124
  v_rcp_f32 v125, v125
  v_rcp_f32 v126, v126
  v_rcp_f32 v127, v127
  s_nop 0
  v_pk_mul_f32 v[124:125], v[124:125], v[128:129]
  v_pk_mul_f32 v[126:127], v[126:127], v[130:131]
  v_cvt_pk_bf16_f32 v30, v124, v125
  v_cvt_pk_bf16_f32 v31, v126, v127
  s_nop 1
  v_permlane16_swap_b32 v28, v30
  v_permlane16_swap_b32 v29, v31
  buffer_store_dwordx4 v[28:31], v12, s[12:15], s33 offen offset:0 sc1
  v_pk_fma_f32 v[44:45], v[108:109], v[20:21], v[44:45] op_sel_hi:[1,0,1]
  v_pk_fma_f32 v[46:47], v[110:111], v[20:21], v[46:47] op_sel_hi:[1,0,1]
  v_pk_fma_f32 v[48:49], v[112:113], v[20:21], v[48:49] op_sel_hi:[1,0,1]
  v_pk_fma_f32 v[50:51], v[114:115], v[20:21], v[50:51] op_sel_hi:[1,0,1]
  v_pk_mul_f32 v[116:117], v[44:45], v[68:69] op_sel_hi:[1,0]
  v_pk_mul_f32 v[118:119], v[46:47], v[68:69] op_sel_hi:[1,0]
  v_exp_f32 v116, v116
  v_exp_f32 v117, v117
  v_exp_f32 v118, v118
  v_exp_f32 v119, v119
  v_pk_mul_f32 v[120:121], v[44:45], v[48:49]
  v_pk_mul_f32 v[122:123], v[46:47], v[50:51]
  v_pk_fma_f32 v[116:117], v[116:117], v[22:23], v[22:23] op_sel_hi:[1,0,0]
  v_pk_fma_f32 v[118:119], v[118:119], v[22:23], v[22:23] op_sel_hi:[1,0,0]
  v_rcp_f32 v116, v116
  v_rcp_f32 v117, v117
  v_rcp_f32 v118, v118
  v_rcp_f32 v119, v119
  s_nop 0
  v_pk_mul_f32 v[116:117], v[116:117], v[120:121]
  v_pk_mul_f32 v[118:119], v[118:119], v[122:123]
  v_cvt_pk_bf16_f32 v32, v116, v117
  v_cvt_pk_bf16_f32 v33, v118, v119
  v_pk_fma_f32 v[60:61], v[108:109], v[24:25], v[60:61] op_sel_hi:[1,0,1]
  v_pk_fma_f32 v[62:63], v[110:111], v[24:25], v[62:63] op_sel_hi:[1,0,1]
  v_pk_fma_f32 v[64:65], v[112:113], v[24:25], v[64:65] op_sel_hi:[1,0,1]
  v_pk_fma_f32 v[66:67], v[114:115], v[24:25], v[66:67] op_sel_hi:[1,0,1]
  v_pk_mul_f32 v[124:125], v[60:61], v[70:71] op_sel_hi:[1,0]
  v_pk_mul_f32 v[126:127], v[62:63], v[70:71] op_sel_hi:[1,0]
  v_exp_f32 v124, v124
  v_exp_f32 v125, v125
  v_exp_f32 v126, v126
  v_exp_f32 v127, v127
  v_pk_mul_f32 v[128:129], v[60:61], v[64:65]
  v_pk_mul_f32 v[130:131], v[62:63], v[66:67]
  v_pk_fma_f32 v[124:125], v[124:125], v[26:27], v[26:27] op_sel_hi:[1,0,0]
  v_pk_fma_f32 v[126:127], v[126:127], v[26:27], v[26:27] op_sel_hi:[1,0,0]
  v_rcp_f32 v124, v124
  v_rcp_f32 v125, v125
  v_rcp_f32 v126, v126
  v_rcp_f32 v127, v127
  s_nop 0
  v_pk_mul_f32 v[124:125], v[124:125], v[128:129]
  v_pk_mul_f32 v[126:127], v[126:127], v[130:131]
  v_cvt_pk_bf16_f32 v34, v124, v125
  v_cvt_pk_bf16_f32 v35, v126, v127
  s_nop 1
  v_permlane16_swap_b32 v32, v34
  v_permlane16_swap_b32 v33, v35
  buffer_store_dwordx4 v[32:35], v12, s[12:15], s33 offen offset:1024 sc1
  s_cmp_eq_u32 s39, 5
  s_cbranch_scc1 KG_OUT
  s_lshl_b32 s33, s44, 10
  s_add_u32 s33, s33, s36
  v_add_u32 v10, 2048, v10
  s_cmp_eq_u32 s32, 1
  s_cbranch_scc1 KG1_IN
  s_barrier
  ds_read_b128 v[68:71], v15 offset:0
  ds_read_b128 v[72:75], v15 offset:256
  ds_read_b128 v[100:103], v17 offset:0
  ds_read_b128 v[104:107], v17 offset:1024
  ds_read_b128 v[108:111], v17 offset:2048
  ds_read_b128 v[112:115], v17 offset:3072
  ds_read_b128 v[76:79], v15 offset:16384
  ds_read_b128 v[80:83], v15 offset:16640
  ds_read_b128 v[116:119], v17 offset:16384
  ds_read_b128 v[120:123], v17 offset:17408
  ds_read_b128 v[124:127], v17 offset:18432
  ds_read_b128 v[128:131], v17 offset:19456
  v_mov_b32 v36, 0
  v_mov_b32 v37, 0
  v_mov_b32 v38, 0
  v_mov_b32 v39, 0
  v_mov_b32 v40, 0
  v_mov_b32 v41, 0
  v_mov_b32 v42, 0
  v_mov_b32 v43, 0
  v_mov_b32 v44, 0
  v_mov_b32 v45, 0
  v_mov_b32 v46, 0
  v_mov_b32 v47, 0
  v_mov_b32 v48, 0
  v_mov_b32 v49, 0
  v_mov_b32 v50, 0
  v_mov_b32 v51, 0
  v_mov_b32 v52, 0
  v_mov_b32 v53, 0
  v_mov_b32 v54, 0
  v_mov_b32 v55, 0
  v_mov_b32 v56, 0
  v_mov_b32 v57, 0
  v_mov_b32 v58, 0
  v_mov_b32 v59, 0
  v_mov_b32 v60, 0
  v_mov_b32 v61, 0
  v_mov_b32 v62, 0
  v_mov_b32 v63, 0
  v_mov_b32 v64, 0
  v_mov_b32 v65, 0
  v_mov_b32 v66, 0
  v_mov_b32 v67, 0
  s_branch KG2_3
KG1_IN:
  s_barrier
  ds_read_b128 v[68:71], v15 offset:0
  ds_read_b128 v[72:75], v15 offset:256
  ds_read_b128 v[100:103], v17 offset:0
  ds_read_b128 v[104:107], v17 offset:1024
  ds_read_b128 v[76:79], v15 offset:16384
  ds_read_b128 v[80:83], v15 offset:16640
  ds_read_b128 v[116:119], v17 offset:16384
  ds_read_b128 v[120:123], v17 offset:17408
  v_mov_b32 v36, 0
  v_mov_b32 v37, 0
  v_mov_b32 v38, 0
  v_mov_b32 v39, 0
  v_mov_b32 v40, 0
  v_mov_b32 v41, 0
  v_mov_b32 v42, 0
  v_mov_b32 v43, 0
  v_mov_b32 v44, 0
  v_mov_b32 v45, 0
  v_mov_b32 v46, 0
  v_mov_b32 v47, 0
  v_mov_b32 v48, 0
  v_mov_b32 v49, 0
  v_mov_b32 v50, 0
  v_mov_b32 v51, 0
  v_mov_b32 v52, 0
  v_mov_b32 v53, 0
  v_mov_b32 v54, 0
  v_mov_b32 v55, 0
  v_mov_b32 v56, 0
  v_mov_b32 v57, 0
  v_mov_b32 v58, 0
  v_mov_b32 v59, 0
  v_mov_b32 v60, 0
  v_mov_b32 v61, 0
  v_mov_b32 v62, 0
  v_mov_b32 v63, 0
  v_mov_b32 v64, 0
  v_mov_b32 v65, 0
  v_mov_b32 v66, 0
  v_mov_b32 v67, 0
  s_branch KG1_3
.p2align 6
KG1_L:
  s_waitcnt vmcnt(0) lgkmcnt(0)
  s_barrier
  v_mfma_f32_16x16x32_bf16 v[36:39], v[132:135], v[84:87], v[36:39]
  ds_read_b128 v[68:71], v14 offset:0
  v_mfma_f32_16x16x32_bf16 v[52:55], v[132:135], v[88:91], v[52:55]
  ds_read_b128 v[72:75], v14 offset:256
  v_mfma_f32_16x16x32_bf16 v[40:43], v[136:139], v[84:87], v[40:43]
  ds_read_b128 v[100:103], v16 offset:0
  v_mfma_f32_16x16x32_bf16 v[56:59], v[136:139], v[88:91], v[56:59]
  ds_read_b128 v[104:107], v16 offset:1024
  v_mfma_f32_16x16x32_bf16 v[36:39], v[148:151], v[92:95], v[36:39]
  ds_read_b128 v[76:79], v14 offset:16384
  v_mfma_f32_16x16x32_bf16 v[52:55], v[148:151], v[96:99], v[52:55]
  ds_read_b128 v[80:83], v14 offset:16640
  v_mfma_f32_16x16x32_bf16 v[40:43], v[152:155], v[92:95], v[40:43]
  ds_read_b128 v[116:119], v16 offset:16384
  v_mfma_f32_16x16x32_bf16 v[56:59], v[152:155], v[96:99], v[56:59]
  ds_read_b128 v[120:123], v16 offset:17408
KG1_1:
  s_waitcnt lgkmcnt(0)
  s_barrier
  v_mfma_f32_16x16x32_bf16 v[36:39], v[100:103], v[68:71], v[36:39]
  ds_read_b128 v[84:87], v14 offset:32768
  v_mfma_f32_16x16x32_bf16 v[52:55], v[100:103], v[72:75], v[52:55]
  ds_read_b128 v[88:91], v14 offset:33024
  v_mfma_f32_16x16x32_bf16 v[40:43], v[104:107], v[68:71], v[40:43]
  ds_read_b128 v[132:135], v16 offset:32768
  v_mfma_f32_16x16x32_bf16 v[56:59], v[104:107], v[72:75], v[56:59]
  ds_read_b128 v[136:139], v16 offset:33792
  v_mfma_f32_16x16x32_bf16 v[36:39], v[116:119], v[76:79], v[36:39]
  ds_read_b128 v[92:95], v14 offset:49152
  v_mfma_f32_16x16x32_bf16 v[52:55], v[116:119], v[80:83], v[52:55]
  ds_read_b128 v[96:99], v14 offset:49408
  v_mfma_f32_16x16x32_bf16 v[40:43], v[120:123], v[76:79], v[40:43]
  ds_read_b128 v[148:151], v16 offset:49152
  v_mfma_f32_16x16x32_bf16 v[56:59], v[120:123], v[80:83], v[56:59]
  ds_read_b128 v[152:155], v16 offset:50176
  s_waitcnt lgkmcnt(0)
  s_barrier
  v_mfma_f32_16x16x32_bf16 v[36:39], v[132:135], v[84:87], v[36:39]
  ds_read_b128 v[68:71], v15 offset:0
  v_mfma_f32_16x16x32_bf16 v[52:55], v[132:135], v[88:91], v[52:55]
  ds_read_b128 v[72:75], v15 offset:256
  v_mfma_f32_16x16x32_bf16 v[40:43], v[136:139], v[84:87], v[40:43]
  ds_read_b128 v[100:103], v17 offset:0
  v_mfma_f32_16x16x32_bf16 v[56:59], v[136:139], v[88:91], v[56:59]
  ds_read_b128 v[104:107], v17 offset:1024
  v_mfma_f32_16x16x32_bf16 v[36:39], v[148:151], v[92:95], v[36:39]
  ds_read_b128 v[76:79], v15 offset:16384
  v_mfma_f32_16x16x32_bf16 v[52:55], v[148:151], v[96:99], v[52:55]
  ds_read_b128 v[80:83], v15 offset:16640
  v_mfma_f32_16x16x32_bf16 v[40:43], v[152:155], v[92:95], v[40:43]
  ds_read_b128 v[116:119], v17 offset:16384
  v_mfma_f32_16x16x32_bf16 v[56:59], v[152:155], v[96:99], v[56:59]
  ds_read_b128 v[120:123], v17 offset:17408
KG1_3:
  s_waitcnt lgkmcnt(0)
  s_barrier
  v_mfma_f32_16x16x32_bf16 v[36:39], v[100:103], v[68:71], v[36:39]
  ds_read_b128 v[84:87], v15 offset:32768
  v_mfma_f32_16x16x32_bf16 v[52:55], v[100:103], v[72:75], v[52:55]
  ds_read_b128 v[88:91], v15 offset:33024
  v_mfma_f32_16x16x32_bf16 v[40:43], v[104:107], v[68:71], v[40:43]
  ds_read_b128 v[132:135], v17 offset:32768
  v_mfma_f32_16x16x32_bf16 v[56:59], v[104:107], v[72:75], v[56:59]
  ds_read_b128 v[136:139], v17 offset:33792
  v_mfma_f32_16x16x32_bf16 v[36:39], v[116:119], v[76:79], v[36:39]
  ds_read_b128 v[92:95], v15 offset:49152
  v_mfma_f32_16x16x32_bf16 v[52:55], v[116:119], v[80:83], v[52:55]
  ds_read_b128 v[96:99], v15 offset:49408
  v_mfma_f32_16x16x32_bf16 v[40:43], v[120:123], v[76:79], v[40:43]
  ds_read_b128 v[148:151], v17 offset:49152
  v_mfma_f32_16x16x32_bf16 v[56:59], v[120:123], v[80:83], v[56:59]
  ds_read_b128 v[152:155], v17 offset:50176
  s_add_u32 s39, s39, 1
  s_cmp_lg_u32 s39, 5
  s_cbranch_scc1 KG1_L
KG1_E:
  s_waitcnt lgkmcnt(0)
  v_mfma_f32_16x16x32_bf16 v[36:39], v[132:135], v[84:87], v[36:39]
  ds_read_b128 v[20:23], v11 offset:0
  ds_read_b128 v[24:27], v11 offset:256
  ds_read_b128 v[100:103], v10 offset:0
  ds_read_b128 v[104:107], v10 offset:1024
  v_mfma_f32_16x16x32_bf16 v[52:55], v[132:135], v[88:91], v[52:55]
  v_mfma_f32_16x16x32_bf16 v[40:43], v[136:139], v[84:87], v[40:43]
  v_mfma_f32_16x16x32_bf16 v[56:59], v[136:139], v[88:91], v[56:59]
  v_mfma_f32_16x16x32_bf16 v[36:39], v[148:151], v[92:95], v[36:39]
  v_mfma_f32_16x16x32_bf16 v[52:55], v[148:151], v[96:99], v[52:55]
  v_mfma_f32_16x16x32_bf16 v[40:43], v[152:155], v[92:95], v[40:43]
  v_mfma_f32_16x16x32_bf16 v[56:59], v[152:155], v[96:99], v[56:59]
  s_waitcnt lgkmcnt(0)
  v_mov_b32 v68, v21
  v_mov_b32 v70, v25
  s_nop 4
  v_pk_fma_f32 v[36:37], v[100:101], v[20:21], v[36:37] op_sel_hi:[1,0,1]
  v_pk_fma_f32 v[38:39], v[102:103], v[20:21], v[38:39] op_sel_hi:[1,0,1]
  v_pk_fma_f32 v[40:41], v[104:105], v[20:21], v[40:41] op_sel_hi:[1,0,1]
  v_pk_fma_f32 v[42:43], v[106:107], v[20:21], v[42:43] op_sel_hi:[1,0,1]
  v_pk_mul_f32 v[116:117], v[36:37], v[68:69] op_sel_hi:[1,0]
  v_pk_mul_f32 v[118:119], v[38:39], v[68:69] op_sel_hi:[1,0]
  v_exp_f32 v116, v116
  v_exp_f32 v117, v117
  v_exp_f32 v118, v118
  v_exp_f32 v119, v119
  v_pk_mul_f32 v[120:121], v[36:37], v[40:41]
  v_pk_mul_f32 v[122:123], v[38:39], v[42:43]
  v_pk_fma_f32 v[116:117], v[116:117], v[22:23], v[22:23] op_sel_hi:[1,0,0]
  v_pk_fma_f32 v[118:119], v[118:119], v[22:23], v[22:23] op_sel_hi:[1,0,0]
  v_rcp_f32 v116, v116
  v_rcp_f32 v117, v117
  v_rcp_f32 v118, v118
  v_rcp_f32 v119, v119
  s_nop 0
  v_pk_mul_f32 v[116:117], v[116:117], v[120:121]
  v_pk_mul_f32 v[118:119], v[118:119], v[122:123]
  v_cvt_pk_bf16_f32 v28, v116, v117
  v_cvt_pk_bf16_f32 v29, v118, v119
  v_pk_fma_f32 v[52:53], v[100:101], v[24:25], v[52:53] op_sel_hi:[1,0,1]
  v_pk_fma_f32 v[54:55], v[102:103], v[24:25], v[54:55] op_sel_hi:[1,0,1]
  v_pk_fma_f32 v[56:57], v[104:105], v[24:25], v[56:57] op_sel_hi:[1,0,1]
  v_pk_fma_f32 v[58:59], v[106:107], v[24:25], v[58:59] op_sel_hi:[1,0,1]
  v_pk_mul_f32 v[124:125], v[52:53], v[70:71] op_sel_hi:[1,0]
  v_pk_mul_f32 v[126:127], v[54:55], v[70:71] op_sel_hi:[1,0]
  v_exp_f32 v124, v124
  v_exp_f32 v125, v125
  v_exp_f32 v126, v126
  v_exp_f32 v127, v127
  v_pk_mul_f32 v[128:129], v[52:53], v[56:57]
  v_pk_mul_f32 v[130:131], v[54:55], v[58:59]
  v_pk_fma_f32 v[124:125], v[124:125], v[26:27], v[26:27] op_sel_hi:[1,0,0]
  v_pk_fma_f32 v[126:127], v[126:127], v[26:27], v[26:27] op_sel_hi:[1,0,0]
  v_rcp_f32 v124, v124
  v_rcp_f32 v125, v125
  v_rcp_f32 v126, v126
  v_rcp_f32 v127, v127
  s_nop 0
  v_pk_mul_f32 v[124:125], v[124:125], v[128:129]
  v_pk_mul_f32 v[126:127], v[126:127], v[130:131]
  v_cvt_pk_bf16_f32 v30, v124, v125
  v_cvt_pk_bf16_f32 v31, v126, v127
  s_nop 1
  v_permlane16_swap_b32 v28, v30
  v_permlane16_swap_b32 v29, v31
  buffer_store_dwordx4 v[28:31], v12, s[12:15], s33 offen offset:0 sc1
KG_OUT:
  v_and_b32 v8, 15, v0
  v_lshrrev_b32 v9, 4, v0
  s_lshr_b32 s34, s6, 1
  s_lshl_b32 s34, s34, 12
  s_and_b32 s36, s6, 1
  s_mul_i32 s35, s36, 2304
  s_add_u32 s34, s34, s35
  s_add_u32 s34, s34, 98304
  v_lshlrev_b32 v13, 9, v9
  v_lshl_add_u32 v13, v8, 4, v13
  v_add_u32 v13, s34, v13
  v_xor_b32 v14, 256, v13
  s_mul_i32 s34, s7, 3072
  s_mul_i32 s35, s36, 5120
  s_add_u32 s34, s34, s35
  v_lshl_add_u32 v15, v0, 4, s34
  v_add_u32 v16, 40960, v15
  v_lshlrev_b32 v20, 16, v2
  v_and_b32 v21, 0xffff0000, v2
  v_lshlrev_b32 v22, 16, v3
  v_and_b32 v23, 0xffff0000, v3
  v_lshlrev_b32 v24, 16, v4
  v_and_b32 v25, 0xffff0000, v4
  v_lshlrev_b32 v26, 16, v5
  v_and_b32 v27, 0xffff0000, v5
  v_lshlrev_b32 v28, 16, v6
  v_and_b32 v29, 0xffff0000, v6
  v_lshlrev_b32 v30, 16, v7
  v_and_b32 v31, 0xffff0000, v7
  v_mov_b32 v32, 0
  v_mov_b32 v33, 0
  v_mov_b32 v34, 0
  v_mov_b32 v35, 0
  v_mov_b32 v36, 0
  v_mov_b32 v37, 0
  v_mov_b32 v38, 0
  v_mov_b32 v39, 0
  v_mov_b32 v40, 0
  v_mov_b32 v41, 0
  v_mov_b32 v42, 0
  v_mov_b32 v43, 0
  s_cmp_eq_u32 s16, 1
  s_cselect_b32 s35, 1, 99
  s_lshr_b32 s37, s40, 1
  s_lshl_b32 s37, s37, 11
  s_add_u32 s37, s37, 23920640
  v_and_b32 v87, 15, v0
  v_lshlrev_b32 v87, 7, v87
  s_mov_b32 s38, 99
  s_cmp_eq_u32 s7, 1
  s_cbranch_scc1 KR1_IN
  s_branch KR0_IN
KB_SLOW:
  s_cmp_eq_u32 s32, 0
  s_cbranch_scc1 KB_S0
  v_mov_b32 v20, v24
  v_mov_b32 v21, v25
  v_mov_b32 v22, v26
  v_mov_b32 v23, v27
  v_mov_b32 v28, v30
  v_mov_b32 v29, v31
KB_S0:
  v_mov_b32 v96, 0
  v_mov_b32 v97, 0
  v_mov_b32 v98, 0
  v_mov_b32 v99, 0
  v_mov_b32 v100, 0
  v_mov_b32 v101, 0
  v_mov_b32 v102, 0
  v_mov_b32 v103, 0
  v_mov_b32 v104, 0
  v_mov_b32 v105, 0
  v_mov_b32 v106, 0
  v_mov_b32 v107, 0
  v_mov_b32 v108, 0
  v_mov_b32 v109, 0
  v_mov_b32 v110, 0
  v_mov_b32 v111, 0
  v_mov_b32 v80, 0xff800000
  v_lshlrev_b32 v84, 3, v8
  v_lshlrev_b32 v85, 4, v9
  v_lshl_add_u32 v85, v8, 5, v85
  v_subrev_u32 v86, 1, v9
  v_and_b32 v28, v28, v86
  s_mul_i32 s36, s17, 163840
  s_add_u32 s36, s36, 3145728
  s_mov_b32 s34, 0
KB_SL:
  s_lshr_b32 s35, s34, 2
  s_mul_i32 s35, s35, 10240
  s_add_u32 s35, s35, s36
  s_and_b32 s37, s34, 3
  s_lshl_b32 s38, s37, 10
  s_add_u32 s38, s38, s35
  buffer_load_dwordx4 v[128:131], v12, s[12:15], s38 offen sc1
  s_lshl_b32 s38, s37, 8
  s_add_u32 s38, s38, s35
  s_add_u32 s38, s38, 4096
  buffer_load_dwordx2 v[136:137], v84, s[12:15], s38 offen sc1
  s_mul_i32 s38, s37, 1280
  s_add_u32 s38, s38, s35
  s_add_u32 s38, s38, 5120
  s_mov_b64 exec, s[48:49]
  buffer_load_dwordx4 v[140:143], v85, s[12:15], s38 offen sc1
  buffer_load_dwordx4 v[148:151], v85, s[12:15], s38 offen offset:640 sc1
  s_mov_b64 exec, -1
  s_waitcnt vmcnt(0)
  v_mfma_f32_32x32x16_bf16 v[48:63], v[128:131], v[20:23], 0
  v_mfma_f32_32x32x8_bf16 v[48:63], v[136:137], v[28:29], v[48:63]
  s_nop 15
  v_max3_f32 v81, v48, v49, v80
  v_max3_f32 v81, v81, v50, v51
  v_max3_f32 v81, v81, v52, v53
  v_max3_f32 v81, v81, v54, v55
  v_max3_f32 v81, v81, v56, v57
  v_max3_f32 v81, v81, v58, v59
  v_max3_f32 v81, v81, v60, v61
  v_max3_f32 v81, v81, v62, v63
  v_mov_b32 v82, v81
  s_nop 1
  v_permlane32_swap_b32 v81, v82
  v_max_f32 v81, v81, v82
  v_sub_f32 v82, v80, v81
  v_exp_f32 v82, v82
  v_mov_b32 v80, v81
  v_sub_f32 v48, v48, v80
  v_sub_f32 v49, v49, v80
  v_sub_f32 v50, v50, v80
  v_sub_f32 v51, v51, v80
  v_sub_f32 v52, v52, v80
  v_sub_f32 v53, v53, v80
  v_sub_f32 v54, v54, v80
  v_sub_f32 v55, v55, v80
  v_sub_f32 v56, v56, v80
  v_sub_f32 v57, v57, v80
  v_sub_f32 v58, v58, v80
  v_sub_f32 v59, v59, v80
  v_sub_f32 v60, v60, v80
  v_sub_f32 v61, v61, v80
  v_sub_f32 v62, v62, v80
  v_sub_f32 v63, v63, v80
  v_exp_f32 v48, v48
  v_exp_f32 v49, v49
  v_exp_f32 v50, v50
  v_exp_f32 v51, v51
  v_exp_f32 v52, v52
  v_exp_f32 v53, v53
  v_exp_f32 v54, v54
  v_exp_f32 v55, v55
  v_exp_f32 v56, v56
  v_exp_f32 v57, v57
  v_exp_f32 v58, v58
  v_exp_f32 v59, v59
  v_exp_f32 v60, v60
  v_exp_f32 v61, v61
  v_exp_f32 v62, v62
  v_exp_f32 v63, v63
  v_mul_f32 v96, v96, v82
  v_mul_f32 v97, v97, v82
  v_mul_f32 v98, v98, v82
  v_mul_f32 v99, v99, v82
  v_mul_f32 v100, v100, v82
  v_mul_f32 v101, v101, v82
  v_mul_f32 v102, v102, v82
  v_mul_f32 v103, v103, v82
  v_mul_f32 v104, v104, v82
  v_mul_f32 v105, v105, v82
  v_mul_f32 v106, v106, v82
  v_mul_f32 v107, v107, v82
  v_mul_f32 v108, v108, v82
  v_mul_f32 v109, v109, v82
  v_mul_f32 v110, v110, v82
  v_mul_f32 v111, v111, v82
  s_nop 1
  v_smfmac_f32_32x32x32_bf16 v[96:111], v[140:143], v[48:55], v16
  v_smfmac_f32_32x32x32_bf16 v[96:111], v[148:151], v[56:63], v16
  s_add_u32 s34, s34, 1
  s_cmp_lt_u32 s34, 64
  s_cbranch_scc1 KB_SL
  s_nop 15
  v_mov_b32 v36, v104
  v_mov_b32 v37, v104
  s_nop 1
  v_permlane32_swap_b32 v36, v37
  s_nop 1
  v_rcp_f32 v36, v37
  s_mov_b64 s[38:39], -1
  s_branch KB_OUT
K_END:
  s_endpgm
CODE_END:
.section .rodata,"a"
.p2align 6
.amdhsa_kernel sequential_preLN__softmax_full_mha__swiglu_ffn__prompt_kernel
  .amdhsa_next_free_vgpr 168
  .amdhsa_next_free_sgpr 102
  .amdhsa_accum_offset 168
  .amdhsa_group_segment_fixed_size 0
  .amdhsa_kernarg_size 80
  .amdhsa_user_sgpr_count 2
  .amdhsa_user_sgpr_kernarg_segment_ptr 1
  .amdhsa_system_sgpr_workgroup_id_x 1
  .amdhsa_float_denorm_mode_32 3
.end_amdhsa_kernel
```
